```python
import torch

def _softmax(x, axis=-1):
    return torch.softmax(x, dim=axis)
def _gelu(x):
    return torch.nn.functional.gelu(x, approximate="tanh")
def _silu(x):
    return torch.nn.functional.silu(x)
def _sigmoid(x):
    return torch.sigmoid(x)
def _layernorm(x, axis=-1, eps=1e-5):
    m = x.mean(dim=axis, keepdim=True)
    v = x.var(dim=axis, keepdim=True, unbiased=False)
    return (x - m) / torch.sqrt(v + eps)
def _scatter_add(tgt, idx, src, axis=0):
    return tgt.clone().index_add_(axis, idx, src)
def _segment_sum(src, seg, n):
    out = torch.zeros((n,) + src.shape[1:], dtype=src.dtype)
    return out.index_add_(0, seg, src)
def _pad(x, pw):
    flat = tuple(v for pair in reversed(pw) for v in pair)
    return torch.nn.functional.pad(x, flat)

kernel_name = 'parallel_sum__sliding_block__moe_arch_mod__prompt'

def setup_inputs():

    _w = (lambda a: (lambda t: t.to(torch.bfloat16) if t.is_floating_point() else t)(torch.as_tensor(a)))
    def _A_setup():
        B, S, D = 1, 2048, 640
        return {
            "x": _w((lambda *s: torch.randn(*s, dtype=torch.bfloat16) * 0.05)(B, S, D)),
            "wqkv": _w((lambda *s: torch.randn(*s, dtype=torch.bfloat16) * 0.05)(D, 3 * D)),
            "wo": _w((lambda *s: torch.randn(*s, dtype=torch.bfloat16) * 0.05)(D, D)),
        }
    _A_in = _A_setup()

    def _B_setup():
        B, S, D, F, C = 1, 2048, 640, 1536, 2
        return {
            "x": _w((lambda *s: torch.randn(*s, dtype=torch.bfloat16) * 0.05)(B, S, D)),
            "w_r": _w((lambda *s: torch.randn(*s, dtype=torch.bfloat16) * 0.05)(D)),
            "w_gate": _w((lambda *s: torch.randn(*s, dtype=torch.bfloat16) * 0.05)(D, F)),
            "w_up": _w((lambda *s: torch.randn(*s, dtype=torch.bfloat16) * 0.05)(D, F)),
            "w_down": _w((lambda *s: torch.randn(*s, dtype=torch.bfloat16) * 0.05)(F, D)),
        }
    _B_in = _B_setup()

    return {
        "A_x": _A_in["x"],
        "A_wqkv": _A_in["wqkv"],
        "A_wo": _A_in["wo"],
        "B_x": _B_in["x"],
        "B_w_r": _B_in["w_r"],
        "B_w_gate": _B_in["w_gate"],
        "B_w_up": _B_in["w_up"],
        "B_w_down": _B_in["w_down"],
    }

def reference(A_x, A_wqkv, A_wo, B_x, B_w_r, B_w_gate, B_w_up, B_w_down):
    def _A_ref(x, wqkv, wo):
        B, S, D = x.shape
        H = 32; Dh = D // H; W = 256
        qkv = (lambda x, *d: x.permute(*d))((x @ wqkv).reshape(B, S, 3, H, Dh), 2, 0, 3, 1, 4)
        q, k, v = qkv[0], qkv[1], qkv[2]
        scores = torch.einsum("bhqd,bhkd->bhqk", q, k) * (Dh ** -0.5)
        idx = torch.arange(S)
        mask = (idx[:, None] - idx[None, :] >= 0) & (idx[:, None] - idx[None, :] < W)
        scores = torch.where(mask[None, None], scores, -1e9)
        p = _softmax(scores, axis=-1)
        o = torch.einsum("bhqk,bhkd->bhqd", p, v)
        return (lambda x, *d: x.permute(*d))(o, 0, 2, 1, 3).reshape(B, S, D) @ wo

    def _B_ref(x, w_r, w_gate, w_up, w_down):
        B, S, D = x.shape
        C = 2
        r = x @ w_r
        idx = torch.argsort(-r, axis=-1)[:, :C]
        idx_e = (lambda x, n, axis: torch.repeat_interleave(x, n, dim=axis))(idx.reshape(B, C, 1), D, axis=2)
        x_sel = (lambda x, i, axis: torch.take_along_dim(x, i, dim=axis))(x, idx_e, axis=1)
        g = _silu(x_sel @ w_gate)
        u = x_sel @ w_up
        y = (g * u) @ w_down
        r_sel = _sigmoid((lambda x, i, axis: torch.take_along_dim(x, i, dim=axis))(r, idx, axis=1))
        y = y * r_sel.reshape(B, C, 1)
        b_off = (torch.arange(B) * S).reshape(B, 1)
        flat_idx = (idx + b_off).reshape(B * C)
        zero = (x * 0.0).reshape(B * S, D)
        upd = _scatter_add(zero, flat_idx, y.reshape(B * C, D), axis=0)
        return x + upd.reshape(B, S, D)

    x = A_x
    xn = _layernorm(x, axis=-1)
    return x + _A_ref(xn, A_wqkv, A_wo) + _B_ref(xn, B_w_r, B_w_gate, B_w_up, B_w_down)
```

```asm
; @launch grid=(256,1,1) block=(512,1,1) lds=158208
.amdgcn_target "amdgcn-amd-amdhsa--gfx950"
.text
.globl parallel_sum__sliding_block__moe_arch_mod__prompt_kernel
.p2align 8
.type parallel_sum__sliding_block__moe_arch_mod__prompt_kernel,@function
parallel_sum__sliding_block__moe_arch_mod__prompt_kernel:
s_cmp_ge_u32 s2, 256
s_cbranch_scc1 L_end
s_load_dwordx16 s[64:79], s[0:1], 0
s_load_dwordx4 s[80:83], s[0:1], 64
s_load_dwordx2 s[84:85], s[0:1], 80
v_lshrrev_b32 v1, 6, v0
v_and_b32 v2, 63, v0
v_readfirstlane_b32 s30, v1
s_and_b32 s28, s2, 7
s_lshr_b32 s29, s2, 3
s_cmp_ge_u32 s29, 30
s_cbranch_scc1 L_aux

s_cmp_ge_u32 s29, 15
s_cselect_b32 s35, 1, 0
s_lshl_b32 s31, s28, 1
s_add_u32 s31, s31, s35
s_mul_i32 s35, s35, 15
s_sub_u32 s32, s29, s35
s_cmp_ge_u32 s30, 4
s_cbranch_scc0 L_g1_compute
s_sub_u32 s34, s30, 4
v_lshrrev_b32 v3, 3, v2
s_lshl_b32 s35, s31, 7
s_lshl_b32 s36, s34, 5
s_add_u32 s35, s35, s36
v_add_u32 v3, s35, v3
v_mul_u32_u24 v6, 1280, v3
v_lshrrev_b32 v4, 4, v2
v_and_b32 v5, 7, v2
v_xor_b32 v7, v4, v5
v_lshlrev_b32 v7, 4, v7
v_add_u32 v10, v6, v7
v_xor_b32 v7, 64, v7
v_add_u32 v11, v6, v7
v_add_u32 v11, 10240, v11
v_lshlrev_b32 v7, 2, v4
v_and_b32 v5, 15, v2
v_xor_b32 v7, v7, v5
v_lshlrev_b32 v7, 4, v7
s_lshl_b32 s36, s34, 4
v_add_u32 v3, s36, v4
v_mul_u32_u24 v3, 3840, v3
v_add_u32 v12, v3, v7
s_lshl_b32 s39, s32, 8
v_add_u32 v12, s39, v12
s_lshl_b32 s48, s34, 12
s_mov_b32 s46, 0
s_mov_b32 s47, 0
s_waitcnt lgkmcnt(0)

s_mov_b32 s4, s64
s_mov_b32 s5, s65
s_mov_b32 s6, 2621440
s_mov_b32 s7, 0x20000
s_mov_b32 s8, s66
s_mov_b32 s9, s67
s_mov_b32 s10, 2457600
s_mov_b32 s11, 0x20000
s_add_u32 m0, s48, 0
s_add_u32 s45, s46, 0
buffer_load_dwordx4 v10, s[4:7], s45 offen lds
s_add_u32 m0, s48, 1024
s_add_u32 s45, s46, 0
buffer_load_dwordx4 v11, s[4:7], s45 offen lds
s_add_u32 m0, s48, 2048
s_add_u32 s45, s46, 20480
buffer_load_dwordx4 v10, s[4:7], s45 offen lds
s_add_u32 m0, s48, 3072
s_add_u32 s45, s46, 20480
buffer_load_dwordx4 v11, s[4:7], s45 offen lds
s_add_u32 m0, s48, 16384
s_add_u32 s45, s47, 0
buffer_load_dwordx4 v12, s[8:11], s45 offen lds
s_add_u32 m0, s48, 17408
s_add_u32 s45, s47, 15360
buffer_load_dwordx4 v12, s[8:11], s45 offen lds
s_add_u32 m0, s48, 18432
s_add_u32 s45, s47, 30720
buffer_load_dwordx4 v12, s[8:11], s45 offen lds
s_add_u32 m0, s48, 19456
s_add_u32 s45, s47, 46080
buffer_load_dwordx4 v12, s[8:11], s45 offen lds
s_add_u32 s46, s46, 128
s_add_u32 s47, s47, 245760
s_add_u32 s48, s48, 32768
s_and_b32 s48, s48, 0x1ffff
s_add_u32 m0, s48, 0
s_add_u32 s45, s46, 0
buffer_load_dwordx4 v10, s[4:7], s45 offen lds
s_add_u32 m0, s48, 1024
s_add_u32 s45, s46, 0
buffer_load_dwordx4 v11, s[4:7], s45 offen lds
s_add_u32 m0, s48, 2048
s_add_u32 s45, s46, 20480
buffer_load_dwordx4 v10, s[4:7], s45 offen lds
s_add_u32 m0, s48, 3072
s_add_u32 s45, s46, 20480
buffer_load_dwordx4 v11, s[4:7], s45 offen lds
s_add_u32 m0, s48, 16384
s_add_u32 s45, s47, 0
buffer_load_dwordx4 v12, s[8:11], s45 offen lds
s_add_u32 m0, s48, 17408
s_add_u32 s45, s47, 15360
buffer_load_dwordx4 v12, s[8:11], s45 offen lds
s_add_u32 m0, s48, 18432
s_add_u32 s45, s47, 30720
buffer_load_dwordx4 v12, s[8:11], s45 offen lds
s_add_u32 m0, s48, 19456
s_add_u32 s45, s47, 46080
buffer_load_dwordx4 v12, s[8:11], s45 offen lds
s_add_u32 s46, s46, 128
s_add_u32 s47, s47, 245760
s_add_u32 s48, s48, 32768
s_and_b32 s48, s48, 0x1ffff
s_mov_b32 s20, s84
s_mov_b32 s21, s85
s_mov_b32 s22, 12582912
s_mov_b32 s23, 0x20000
s_mov_b32 s16, s82
s_mov_b32 s17, s83
s_mov_b32 s18, 256
s_mov_b32 s19, 0x20000
s_waitcnt vmcnt(8)
s_barrier
s_add_u32 m0, s48, 0
s_add_u32 s45, s46, 0
buffer_load_dwordx4 v10, s[4:7], s45 offen lds
s_add_u32 m0, s48, 1024
s_add_u32 s45, s46, 0
buffer_load_dwordx4 v11, s[4:7], s45 offen lds
s_add_u32 m0, s48, 2048
s_add_u32 s45, s46, 20480
buffer_load_dwordx4 v10, s[4:7], s45 offen lds
s_add_u32 m0, s48, 3072
s_add_u32 s45, s46, 20480
buffer_load_dwordx4 v11, s[4:7], s45 offen lds
s_add_u32 m0, s48, 16384
s_add_u32 s45, s47, 0
buffer_load_dwordx4 v12, s[8:11], s45 offen lds
s_add_u32 m0, s48, 17408
s_add_u32 s45, s47, 15360
buffer_load_dwordx4 v12, s[8:11], s45 offen lds
s_add_u32 m0, s48, 18432
s_add_u32 s45, s47, 30720
buffer_load_dwordx4 v12, s[8:11], s45 offen lds
s_add_u32 m0, s48, 19456
s_add_u32 s45, s47, 46080
buffer_load_dwordx4 v12, s[8:11], s45 offen lds
s_add_u32 s46, s46, 128
s_add_u32 s47, s47, 245760
s_add_u32 s48, s48, 32768
s_and_b32 s48, s48, 0x1ffff
s_waitcnt vmcnt(8)
s_barrier
s_add_u32 m0, s48, 0
s_add_u32 s45, s46, 0
buffer_load_dwordx4 v10, s[4:7], s45 offen lds
s_add_u32 m0, s48, 1024
s_add_u32 s45, s46, 0
buffer_load_dwordx4 v11, s[4:7], s45 offen lds
s_add_u32 m0, s48, 2048
s_add_u32 s45, s46, 20480
buffer_load_dwordx4 v10, s[4:7], s45 offen lds
s_add_u32 m0, s48, 3072
s_add_u32 s45, s46, 20480
buffer_load_dwordx4 v11, s[4:7], s45 offen lds
s_add_u32 m0, s48, 16384
s_add_u32 s45, s47, 0
buffer_load_dwordx4 v12, s[8:11], s45 offen lds
s_add_u32 m0, s48, 17408
s_add_u32 s45, s47, 15360
buffer_load_dwordx4 v12, s[8:11], s45 offen lds
s_add_u32 m0, s48, 18432
s_add_u32 s45, s47, 30720
buffer_load_dwordx4 v12, s[8:11], s45 offen lds
s_add_u32 m0, s48, 19456
s_add_u32 s45, s47, 46080
buffer_load_dwordx4 v12, s[8:11], s45 offen lds
s_add_u32 s46, s46, 128
s_add_u32 s47, s47, 245760
s_add_u32 s48, s48, 32768
s_and_b32 s48, s48, 0x1ffff
s_mov_b32 s49, 6
L_ld_loop:
s_add_u32 m0, s48, 0
s_add_u32 s45, s46, 0
buffer_load_dwordx4 v10, s[4:7], s45 offen lds
s_add_u32 m0, s48, 1024
s_add_u32 s45, s46, 0
buffer_load_dwordx4 v11, s[4:7], s45 offen lds
s_add_u32 m0, s48, 2048
s_add_u32 s45, s46, 20480
buffer_load_dwordx4 v10, s[4:7], s45 offen lds
s_add_u32 m0, s48, 3072
s_add_u32 s45, s46, 20480
buffer_load_dwordx4 v11, s[4:7], s45 offen lds
s_add_u32 m0, s48, 16384
s_add_u32 s45, s47, 0
buffer_load_dwordx4 v12, s[8:11], s45 offen lds
s_add_u32 m0, s48, 17408
s_add_u32 s45, s47, 15360
buffer_load_dwordx4 v12, s[8:11], s45 offen lds
s_add_u32 m0, s48, 18432
s_add_u32 s45, s47, 30720
buffer_load_dwordx4 v12, s[8:11], s45 offen lds
s_add_u32 m0, s48, 19456
s_add_u32 s45, s47, 46080
buffer_load_dwordx4 v12, s[8:11], s45 offen lds
s_add_u32 s46, s46, 128
s_add_u32 s47, s47, 245760
s_add_u32 s48, s48, 32768
s_and_b32 s48, s48, 0x1ffff
s_waitcnt vmcnt(16)
s_barrier
s_sub_u32 s49, s49, 1
s_cmp_lg_u32 s49, 0
s_cbranch_scc1 L_ld_loop
s_waitcnt vmcnt(8)
s_barrier
buffer_load_dword v13, off, s[16:19], 0 sc1
s_waitcnt vmcnt(1)
s_barrier
s_waitcnt vmcnt(0)
v_readfirstlane_b32 s26, v13
s_nop 3
s_cmp_lg_u32 s26, 0
s_cbranch_scc1 L_ld_gotn
s_mov_b32 s27, 0x20000
L_gn1:
buffer_load_dword v13, off, s[16:19], 0 sc1
s_waitcnt vmcnt(0)
v_readfirstlane_b32 s26, v13
s_sub_u32 s27, s27, 1
s_cmp_lg_u32 s26, 0
s_cbranch_scc1 L_gnd1
s_sleep 1
s_cmp_lg_u32 s27, 0
s_cbranch_scc1 L_gn1
L_gnd1:
L_ld_gotn:
s_branch L_g1_join
L_g1_compute:
s_and_b32 s34, s30, 1
s_lshr_b32 s35, s30, 1
v_and_b32 v3, 31, v2
v_lshrrev_b32 v4, 5, v2
v_lshrrev_b32 v5, 1, v2
v_and_b32 v5, 7, v5
v_xor_b32 v5, v5, v4
v_lshlrev_b32 v5, 4, v5
v_lshlrev_b32 v6, 7, v3
v_add_u32 v5, v5, v6
s_lshl_b32 s36, s35, 1
s_add_u32 s37, s36, s34
s_xor_b32 s38, s37, 1
s_lshl_b32 s39, s37, 12
s_lshl_b32 s40, s38, 12

s_waitcnt lgkmcnt(0)
s_mov_b32 s20, s84
s_mov_b32 s21, s85
s_mov_b32 s22, 12582912
s_mov_b32 s23, 0x20000
s_mov_b32 s16, s82
s_mov_b32 s17, s83
s_mov_b32 s18, 256
s_mov_b32 s19, 0x20000
s_mov_b32 s4, s64
s_mov_b32 s5, s65
s_mov_b32 s6, 2621440
s_mov_b32 s7, 0x20000
s_or_b32 s50, s2, s30
s_cmp_lg_u32 s50, 0
s_cbranch_scc1 L_np_skip
s_memrealtime s[46:47]
s_waitcnt lgkmcnt(0)
s_or_b32 s46, s46, 1
v_mov_b32 v20, s46
s_mov_b64 exec, 1
buffer_store_dword v20, off, s[16:19], 0 sc1
s_mov_b64 exec, -1
L_np_skip:

s_mov_b32 s8, s66
s_mov_b32 s9, s67
s_mov_b32 s10, 2457600
s_mov_b32 s11, 0x20000
s_bitcmp1_b32 s30, 0
s_cbranch_scc1 L_pf_w
v_mul_u32_u24 v20, 52429, v2
v_lshrrev_b32 v20, 18, v20
v_mul_u32_u24 v21, 5, v20
v_sub_u32 v21, v2, v21
s_lshl_b32 s50, s28, 8
s_lshl_b32 s51, s29, 3
s_add_u32 s50, s50, s51
v_add_u32 v20, s50, v20
v_mul_u32_u24 v20, 1280, v20
v_lshlrev_b32 v21, 7, v21
v_add_u32 v20, v20, v21
s_lshr_b32 s50, s30, 1
s_mul_i32 s50, s50, 640
v_add_u32 v20, s50, v20
v_mov_b32 v22, -1
v_cmp_gt_u32 vcc, 40, v2
s_nop 1
v_cndmask_b32 v20, v22, v20, vcc
buffer_load_dword v250, v20, s[4:7], 0 offen
s_branch L_pf_d
L_pf_w:
s_mul_i32 s50, s2, 38
v_add_u32 v20, s50, v2
v_lshlrev_b32 v20, 7, v20
s_lshr_b32 s50, s30, 1
s_mul_i32 s50, s50, 1228800
v_add_u32 v20, s50, v20
v_mov_b32 v22, -1
v_cmp_gt_u32 vcc, 38, v2
s_nop 1
v_cndmask_b32 v20, v22, v20, vcc
buffer_load_dword v250, v20, s[8:11], 0 offen
L_pf_d:
s_cmp_eq_u32 s30, 3
s_cbranch_scc0 L_pf_wo_d
s_mul_i32 s50, s2, 27
v_add_u32 v20, s50, v2
v_lshlrev_b32 v20, 7, v20
v_mov_b32 v22, -1
v_cmp_gt_u32 vcc, 27, v2
s_nop 1
v_cndmask_b32 v20, v22, v20, vcc
s_mov_b32 s12, s68
s_mov_b32 s13, s69
s_mov_b32 s14, 819200
s_mov_b32 s15, 0x20000
buffer_load_dword v252, v20, s[12:15], 0 offen
L_pf_wo_d:

v_xor_b32 v6, 0, v5
v_add_u32 v16, s39, v6
v_add_u32 v20, s40, v6
v_xor_b32 v6, 32, v5
v_add_u32 v17, s39, v6
v_add_u32 v21, s40, v6
v_xor_b32 v6, 64, v5
v_add_u32 v18, s39, v6
v_add_u32 v22, s40, v6
v_xor_b32 v6, 96, v5
v_add_u32 v19, s39, v6
v_add_u32 v23, s40, v6

v_lshrrev_b32 v5, 4, v2
v_bfe_u32 v6, v2, 2, 2
v_and_b32 v7, 3, v2
v_lshrrev_b32 v8, 1, v5
v_lshlrev_b32 v8, 3, v8
v_add_u32 v8, v8, v6
v_lshlrev_b32 v8, 8, v8
v_and_b32 v9, 1, v5
v_lshlrev_b32 v9, 5, v9
v_add_u32 v8, v8, v9
v_lshlrev_b32 v7, 3, v7
v_add_u32 v8, v8, v7
v_add_u32 v8, 16384, v8
s_lshl_b32 s36, s34, 1
s_add_u32 s41, s36, s35
s_xor_b32 s42, s41, 1
v_xor_b32 v9, s41, v6
v_lshlrev_b32 v9, 6, v9
v_add_u32 v24, v8, v9
v_xor_b32 v9, s42, v6
v_lshlrev_b32 v9, 6, v9
v_add_u32 v25, v8, v9
v_and_b32 v8, 15, v2
v_and_b32 v9, 1, v5
v_cmp_eq_u32 vcc, v8, v9
v_mov_b32 v9, 0x3f803f80
s_nop 0
v_cndmask_b32 v28, 0, v9, vcc
v_mov_b32 v29, v28
v_mov_b32 v30, v28
v_mov_b32 v31, v28
s_lshl_b32 s39, s31, 7
s_lshl_b32 s40, s37, 5
s_add_u32 s40, s40, s39
v_add_u32 v137, s40, v3
s_lshl_b32 s40, s38, 5
s_add_u32 s40, s40, s39
v_add_u32 v138, s40, v3
v_lshlrev_b32 v139, 4, v137
v_lshlrev_b32 v140, 4, v138

v_mov_b32 v64, 0
v_mov_b32 v65, 0
v_mov_b32 v66, 0
v_mov_b32 v67, 0
v_mov_b32 v68, 0
v_mov_b32 v69, 0
v_mov_b32 v70, 0
v_mov_b32 v71, 0
v_mov_b32 v72, 0
v_mov_b32 v73, 0
v_mov_b32 v74, 0
v_mov_b32 v75, 0
v_mov_b32 v76, 0
v_mov_b32 v77, 0
v_mov_b32 v78, 0
v_mov_b32 v79, 0
v_mov_b32 v80, 0
v_mov_b32 v81, 0
v_mov_b32 v82, 0
v_mov_b32 v83, 0
v_mov_b32 v84, 0
v_mov_b32 v85, 0
v_mov_b32 v86, 0
v_mov_b32 v87, 0
v_mov_b32 v88, 0
v_mov_b32 v89, 0
v_mov_b32 v90, 0
v_mov_b32 v91, 0
v_mov_b32 v92, 0
v_mov_b32 v93, 0
v_mov_b32 v94, 0
v_mov_b32 v95, 0
v_mov_b32 v96, 0
v_mov_b32 v97, 0
v_mov_b32 v98, 0
v_mov_b32 v99, 0
v_mov_b32 v100, 0
v_mov_b32 v101, 0
v_mov_b32 v102, 0
v_mov_b32 v103, 0
v_mov_b32 v104, 0
v_mov_b32 v105, 0
v_mov_b32 v106, 0
v_mov_b32 v107, 0
v_mov_b32 v108, 0
v_mov_b32 v109, 0
v_mov_b32 v110, 0
v_mov_b32 v111, 0
v_mov_b32 v112, 0
v_mov_b32 v113, 0
v_mov_b32 v114, 0
v_mov_b32 v115, 0
v_mov_b32 v116, 0
v_mov_b32 v117, 0
v_mov_b32 v118, 0
v_mov_b32 v119, 0
v_mov_b32 v120, 0
v_mov_b32 v121, 0
v_mov_b32 v122, 0
v_mov_b32 v123, 0
v_mov_b32 v124, 0
v_mov_b32 v125, 0
v_mov_b32 v126, 0
v_mov_b32 v127, 0
v_mov_b32 v12, 0
v_mov_b32 v13, 0
v_mov_b32 v14, 0
v_mov_b32 v15, 0
s_barrier
ds_read_b64_tr_b16 v[32:33], v24 offset:0
ds_read_b64_tr_b16 v[34:35], v24 offset:1024
ds_read_b128 v[40:43], v16 offset:0
ds_read_b128 v[44:47], v20 offset:0
ds_read_b64_tr_b16 v[36:37], v25 offset:0
ds_read_b64_tr_b16 v[38:39], v25 offset:1024
s_mov_b32 s49, 5
L_c_loop:
s_cmp_eq_u32 s49, 1
s_cbranch_scc0 L_c_l1
buffer_load_dword v136, off, s[16:19], 0 sc1
s_mov_b32 s50, 11534336
buffer_load_dwordx4 v[128:131], v139, s[20:23], s50 offen sc1
buffer_load_dwordx4 v[132:135], v140, s[20:23], s50 offen sc1
L_c_l1:
s_cmp_eq_u32 s49, 2
s_cbranch_scc0 L_c_ns
s_lshl_b32 s50, s29, 6
v_add_u32 v141, s50, v2
s_cmp_ge_u32 s30, 2
s_cbranch_scc1 L_c_td
s_mov_b32 s51, 0x55555556
v_mul_hi_u32 v142, v141, s51
v_mul_u32_u24 v143, 3, v142
v_sub_u32 v143, v141, v143
v_mul_u32_u24 v142, 3072, v142
v_lshlrev_b32 v143, 7, v143
v_add_u32 v142, v142, v143
s_mul_i32 s50, s28, 384
s_cmp_eq_u32 s30, 0
s_cselect_b32 s12, s74, s76
s_cselect_b32 s13, s75, s77
s_mov_b32 s14, 1966080
s_mov_b32 s15, 0x20000
buffer_load_dword v251, v142, s[12:15], s50 offen
s_branch L_c_ns
L_c_td:
s_mov_b32 s51, 429496730
v_mul_hi_u32 v142, v141, s51
v_mul_u32_u24 v143, 10, v142
v_sub_u32 v143, v141, v143
v_mul_u32_u24 v142, 1280, v142
v_lshlrev_b32 v143, 7, v143
v_add_u32 v142, v142, v143
s_mul_i32 s50, s28, 245760

s_mov_b32 s12, s78
s_mov_b32 s13, s79
s_mov_b32 s14, 1966080
s_mov_b32 s15, 0x20000
buffer_load_dword v251, v142, s[12:15], s50 offen
L_c_ns:
s_waitcnt lgkmcnt(3)
v_mfma_f32_32x32x16_bf16 v[64:79], v[32:35], v[40:43], v[64:79]
ds_read_b64_tr_b16 v[48:49], v24 offset:4096
ds_read_b64_tr_b16 v[50:51], v24 offset:5120
s_waitcnt lgkmcnt(4)
v_mfma_f32_32x32x16_bf16 v[80:95], v[32:35], v[44:47], v[80:95]
ds_read_b128 v[56:59], v17 offset:0
ds_read_b128 v[60:63], v21 offset:0
s_waitcnt lgkmcnt(4)
v_mfma_f32_32x32x16_bf16 v[96:111], v[36:39], v[40:43], v[96:111]
ds_read_b64_tr_b16 v[52:53], v25 offset:4096
ds_read_b64_tr_b16 v[54:55], v25 offset:5120
v_mfma_f32_32x32x16_bf16 v[112:127], v[36:39], v[44:47], v[112:127]
v_mfma_f32_16x16x32_bf16 v[12:15], v[32:35], v[28:31], v[12:15]
s_waitcnt lgkmcnt(3)
v_mfma_f32_32x32x16_bf16 v[64:79], v[48:51], v[56:59], v[64:79]
ds_read_b64_tr_b16 v[32:33], v24 offset:8192
ds_read_b64_tr_b16 v[34:35], v24 offset:9216
s_waitcnt lgkmcnt(4)
v_mfma_f32_32x32x16_bf16 v[80:95], v[48:51], v[60:63], v[80:95]
ds_read_b128 v[40:43], v18 offset:0
ds_read_b128 v[44:47], v22 offset:0
s_waitcnt lgkmcnt(4)
v_mfma_f32_32x32x16_bf16 v[96:111], v[52:55], v[56:59], v[96:111]
ds_read_b64_tr_b16 v[36:37], v25 offset:8192
ds_read_b64_tr_b16 v[38:39], v25 offset:9216
v_mfma_f32_32x32x16_bf16 v[112:127], v[52:55], v[60:63], v[112:127]
v_mfma_f32_16x16x32_bf16 v[12:15], v[48:51], v[28:31], v[12:15]
s_waitcnt lgkmcnt(3)
v_mfma_f32_32x32x16_bf16 v[64:79], v[32:35], v[40:43], v[64:79]
ds_read_b64_tr_b16 v[48:49], v24 offset:12288
ds_read_b64_tr_b16 v[50:51], v24 offset:13312
s_waitcnt lgkmcnt(4)
v_mfma_f32_32x32x16_bf16 v[80:95], v[32:35], v[44:47], v[80:95]
ds_read_b128 v[56:59], v19 offset:0
ds_read_b128 v[60:63], v23 offset:0
s_waitcnt lgkmcnt(4)
v_mfma_f32_32x32x16_bf16 v[96:111], v[36:39], v[40:43], v[96:111]
ds_read_b64_tr_b16 v[52:53], v25 offset:12288
ds_read_b64_tr_b16 v[54:55], v25 offset:13312
v_mfma_f32_32x32x16_bf16 v[112:127], v[36:39], v[44:47], v[112:127]
v_mfma_f32_16x16x32_bf16 v[12:15], v[32:35], v[28:31], v[12:15]
s_waitcnt lgkmcnt(0)
s_barrier
v_mfma_f32_32x32x16_bf16 v[64:79], v[48:51], v[56:59], v[64:79]
ds_read_b64_tr_b16 v[32:33], v24 offset:32768
ds_read_b64_tr_b16 v[34:35], v24 offset:33792
v_mfma_f32_32x32x16_bf16 v[80:95], v[48:51], v[60:63], v[80:95]
ds_read_b128 v[40:43], v16 offset:32768
ds_read_b128 v[44:47], v20 offset:32768
v_mfma_f32_32x32x16_bf16 v[96:111], v[52:55], v[56:59], v[96:111]
ds_read_b64_tr_b16 v[36:37], v25 offset:32768
ds_read_b64_tr_b16 v[38:39], v25 offset:33792
v_mfma_f32_32x32x16_bf16 v[112:127], v[52:55], v[60:63], v[112:127]
v_mfma_f32_16x16x32_bf16 v[12:15], v[48:51], v[28:31], v[12:15]
s_waitcnt lgkmcnt(3)
v_mfma_f32_32x32x16_bf16 v[64:79], v[32:35], v[40:43], v[64:79]
ds_read_b64_tr_b16 v[48:49], v24 offset:36864
ds_read_b64_tr_b16 v[50:51], v24 offset:37888
s_waitcnt lgkmcnt(4)
v_mfma_f32_32x32x16_bf16 v[80:95], v[32:35], v[44:47], v[80:95]
ds_read_b128 v[56:59], v17 offset:32768
ds_read_b128 v[60:63], v21 offset:32768
s_waitcnt lgkmcnt(4)
v_mfma_f32_32x32x16_bf16 v[96:111], v[36:39], v[40:43], v[96:111]
ds_read_b64_tr_b16 v[52:53], v25 offset:36864
ds_read_b64_tr_b16 v[54:55], v25 offset:37888
v_mfma_f32_32x32x16_bf16 v[112:127], v[36:39], v[44:47], v[112:127]
v_mfma_f32_16x16x32_bf16 v[12:15], v[32:35], v[28:31], v[12:15]
s_waitcnt lgkmcnt(3)
v_mfma_f32_32x32x16_bf16 v[64:79], v[48:51], v[56:59], v[64:79]
ds_read_b64_tr_b16 v[32:33], v24 offset:40960
ds_read_b64_tr_b16 v[34:35], v24 offset:41984
s_waitcnt lgkmcnt(4)
v_mfma_f32_32x32x16_bf16 v[80:95], v[48:51], v[60:63], v[80:95]
ds_read_b128 v[40:43], v18 offset:32768
ds_read_b128 v[44:47], v22 offset:32768
s_waitcnt lgkmcnt(4)
v_mfma_f32_32x32x16_bf16 v[96:111], v[52:55], v[56:59], v[96:111]
ds_read_b64_tr_b16 v[36:37], v25 offset:40960
ds_read_b64_tr_b16 v[38:39], v25 offset:41984
v_mfma_f32_32x32x16_bf16 v[112:127], v[52:55], v[60:63], v[112:127]
v_mfma_f32_16x16x32_bf16 v[12:15], v[48:51], v[28:31], v[12:15]
s_waitcnt lgkmcnt(3)
v_mfma_f32_32x32x16_bf16 v[64:79], v[32:35], v[40:43], v[64:79]
ds_read_b64_tr_b16 v[48:49], v24 offset:45056
ds_read_b64_tr_b16 v[50:51], v24 offset:46080
s_waitcnt lgkmcnt(4)
v_mfma_f32_32x32x16_bf16 v[80:95], v[32:35], v[44:47], v[80:95]
ds_read_b128 v[56:59], v19 offset:32768
ds_read_b128 v[60:63], v23 offset:32768
s_waitcnt lgkmcnt(4)
v_mfma_f32_32x32x16_bf16 v[96:111], v[36:39], v[40:43], v[96:111]
ds_read_b64_tr_b16 v[52:53], v25 offset:45056
ds_read_b64_tr_b16 v[54:55], v25 offset:46080
v_mfma_f32_32x32x16_bf16 v[112:127], v[36:39], v[44:47], v[112:127]
v_mfma_f32_16x16x32_bf16 v[12:15], v[32:35], v[28:31], v[12:15]
s_waitcnt lgkmcnt(0)
s_sub_u32 s49, s49, 1
s_cmp_eq_u32 s49, 0
s_cbranch_scc1 L_c_tail
s_barrier
v_xor_b32 v16, 0x10000, v16
v_xor_b32 v17, 0x10000, v17
v_xor_b32 v18, 0x10000, v18
v_xor_b32 v19, 0x10000, v19
v_xor_b32 v20, 0x10000, v20
v_xor_b32 v21, 0x10000, v21
v_xor_b32 v22, 0x10000, v22
v_xor_b32 v23, 0x10000, v23
v_xor_b32 v24, 0x10000, v24
v_xor_b32 v25, 0x10000, v25
v_mfma_f32_32x32x16_bf16 v[64:79], v[48:51], v[56:59], v[64:79]
ds_read_b64_tr_b16 v[32:33], v24 offset:0
ds_read_b64_tr_b16 v[34:35], v24 offset:1024
v_mfma_f32_32x32x16_bf16 v[80:95], v[48:51], v[60:63], v[80:95]
ds_read_b128 v[40:43], v16 offset:0
ds_read_b128 v[44:47], v20 offset:0
v_mfma_f32_32x32x16_bf16 v[96:111], v[52:55], v[56:59], v[96:111]
ds_read_b64_tr_b16 v[36:37], v25 offset:0
ds_read_b64_tr_b16 v[38:39], v25 offset:1024
v_mfma_f32_32x32x16_bf16 v[112:127], v[52:55], v[60:63], v[112:127]
v_mfma_f32_16x16x32_bf16 v[12:15], v[48:51], v[28:31], v[12:15]
s_branch L_c_loop
L_c_tail:
v_mfma_f32_32x32x16_bf16 v[64:79], v[48:51], v[56:59], v[64:79]
v_mfma_f32_32x32x16_bf16 v[80:95], v[48:51], v[60:63], v[80:95]
v_mfma_f32_32x32x16_bf16 v[96:111], v[52:55], v[56:59], v[96:111]
v_mfma_f32_32x32x16_bf16 v[112:127], v[52:55], v[60:63], v[112:127]
v_mfma_f32_16x16x32_bf16 v[12:15], v[48:51], v[28:31], v[12:15]

v_and_b32 v8, 15, v2
v_lshlrev_b32 v9, 6, v8
v_lshrrev_b32 v10, 4, v2
v_lshlrev_b32 v10, 4, v10
v_add_u32 v9, v9, v10
s_lshl_b32 s39, s41, 7
s_add_u32 s39, s39, 152064
v_add_u32 v9, s39, v9
v_cmp_gt_u32 vcc, 2, v8
v_lshlrev_b32 v22, 3, v137
v_lshlrev_b32 v20, 14, v4
v_add_u32 v22, v22, v20
v_lshlrev_b32 v23, 3, v138
v_add_u32 v23, v23, v20
s_and_saveexec_b64 s[60:61], vcc
ds_write_b128 v9, v[12:15]
s_mov_b64 exec, s[60:61]
v_lshlrev_b32 v8, 4, v4
v_add_u32 v8, s39, v8
v_xor_b32 v9, 128, v8
s_waitcnt lgkmcnt(0)
s_barrier

ds_read_b128 v[32:35], v8 offset:0
ds_read_b128 v[36:39], v8 offset:32
ds_read_b128 v[40:43], v8 offset:64
ds_read_b128 v[44:47], v8 offset:96
ds_read_b128 v[48:51], v9 offset:0
ds_read_b128 v[52:55], v9 offset:32
ds_read_b128 v[56:59], v9 offset:64
ds_read_b128 v[60:63], v9 offset:96

s_mov_b32 s27, 0x20000
s_waitcnt vmcnt(0)
s_branch L_st_chk2
L_st_chk:
s_waitcnt vmcnt(0)
L_st_chk2:
v_readfirstlane_b32 s26, v136
s_sub_u32 s27, s27, 1
s_nop 1
v_cmp_eq_u32 vcc, s26, v131
v_cmp_eq_u32 s[56:57], s26, v135
s_cmp_eq_u32 s26, 0
s_cbranch_scc1 L_st_retry
s_nop 2
s_and_b64 vcc, vcc, s[56:57]
s_cmp_eq_u64 vcc, -1
s_cbranch_scc1 L_st_ok
L_st_retry:
s_cmp_eq_u32 s27, 0
s_cbranch_scc1 L_st_ok

buffer_load_dword v136, off, s[16:19], 0 sc1
s_mov_b32 s50, 11534336
buffer_load_dwordx4 v[128:131], v139, s[20:23], s50 offen sc1
buffer_load_dwordx4 v[132:135], v140, s[20:23], s50 offen sc1
s_branch L_st_chk
L_st_ok:
s_mov_b32 s44, 1.0
s_mov_b32 s45, 0x3ea52b5c
s_cmp_lt_u32 s32, 5
s_cselect_b32 s44, s45, s44
s_lshl_b32 s50, s32, 5
s_lshl_b32 s51, s41, 3
s_add_u32 s51, s51, s50
s_lshl_b32 s51, s51, 14
s_lshl_b32 s52, s42, 3
s_add_u32 s52, s52, s50
s_lshl_b32 s52, s52, 14
s_waitcnt lgkmcnt(0)
v_mul_f32 v129, s44, v129
v_mul_f32 v133, s44, v133
v_mul_f32 v128, v128, v129
v_mul_f32 v132, v132, v133

s_add_u32 s55, s51, 0
v_pk_mul_f32 v[24:25], v[64:65], v[128:129] op_sel:[0,1] op_sel_hi:[1,1]
v_pk_mul_f32 v[26:27], v[66:67], v[128:129] op_sel:[0,1] op_sel_hi:[1,1]
v_pk_fma_f32 v[24:25], v[32:33], v[128:129], v[24:25] op_sel:[0,0,0] op_sel_hi:[1,0,1] neg_lo:[0,1,0] neg_hi:[0,1,0]
v_pk_fma_f32 v[26:27], v[34:35], v[128:129], v[26:27] op_sel:[0,0,0] op_sel_hi:[1,0,1] neg_lo:[0,1,0] neg_hi:[0,1,0]
v_cvt_pk_bf16_f32 v24, v24, v25
v_cvt_pk_bf16_f32 v25, v26, v27
buffer_store_dwordx2 v[24:25], v22, s[20:23], s55 offen sc1
v_pk_mul_f32 v[28:29], v[80:81], v[132:133] op_sel:[0,1] op_sel_hi:[1,1]
v_pk_mul_f32 v[30:31], v[82:83], v[132:133] op_sel:[0,1] op_sel_hi:[1,1]
v_pk_fma_f32 v[28:29], v[32:33], v[132:133], v[28:29] op_sel:[0,0,0] op_sel_hi:[1,0,1] neg_lo:[0,1,0] neg_hi:[0,1,0]
v_pk_fma_f32 v[30:31], v[34:35], v[132:133], v[30:31] op_sel:[0,0,0] op_sel_hi:[1,0,1] neg_lo:[0,1,0] neg_hi:[0,1,0]
v_cvt_pk_bf16_f32 v28, v28, v29
v_cvt_pk_bf16_f32 v29, v30, v31
buffer_store_dwordx2 v[28:29], v23, s[20:23], s55 offen sc1
s_add_u32 s55, s51, 32768
v_pk_mul_f32 v[8:9], v[68:69], v[128:129] op_sel:[0,1] op_sel_hi:[1,1]
v_pk_mul_f32 v[10:11], v[70:71], v[128:129] op_sel:[0,1] op_sel_hi:[1,1]
v_pk_fma_f32 v[8:9], v[36:37], v[128:129], v[8:9] op_sel:[0,0,0] op_sel_hi:[1,0,1] neg_lo:[0,1,0] neg_hi:[0,1,0]
v_pk_fma_f32 v[10:11], v[38:39], v[128:129], v[10:11] op_sel:[0,0,0] op_sel_hi:[1,0,1] neg_lo:[0,1,0] neg_hi:[0,1,0]
v_cvt_pk_bf16_f32 v8, v8, v9
v_cvt_pk_bf16_f32 v9, v10, v11
buffer_store_dwordx2 v[8:9], v22, s[20:23], s55 offen sc1
v_pk_mul_f32 v[12:13], v[84:85], v[132:133] op_sel:[0,1] op_sel_hi:[1,1]
v_pk_mul_f32 v[14:15], v[86:87], v[132:133] op_sel:[0,1] op_sel_hi:[1,1]
v_pk_fma_f32 v[12:13], v[36:37], v[132:133], v[12:13] op_sel:[0,0,0] op_sel_hi:[1,0,1] neg_lo:[0,1,0] neg_hi:[0,1,0]
v_pk_fma_f32 v[14:15], v[38:39], v[132:133], v[14:15] op_sel:[0,0,0] op_sel_hi:[1,0,1] neg_lo:[0,1,0] neg_hi:[0,1,0]
v_cvt_pk_bf16_f32 v12, v12, v13
v_cvt_pk_bf16_f32 v13, v14, v15
buffer_store_dwordx2 v[12:13], v23, s[20:23], s55 offen sc1
s_add_u32 s55, s51, 65536
v_pk_mul_f32 v[24:25], v[72:73], v[128:129] op_sel:[0,1] op_sel_hi:[1,1]
v_pk_mul_f32 v[26:27], v[74:75], v[128:129] op_sel:[0,1] op_sel_hi:[1,1]
v_pk_fma_f32 v[24:25], v[40:41], v[128:129], v[24:25] op_sel:[0,0,0] op_sel_hi:[1,0,1] neg_lo:[0,1,0] neg_hi:[0,1,0]
v_pk_fma_f32 v[26:27], v[42:43], v[128:129], v[26:27] op_sel:[0,0,0] op_sel_hi:[1,0,1] neg_lo:[0,1,0] neg_hi:[0,1,0]
v_cvt_pk_bf16_f32 v24, v24, v25
v_cvt_pk_bf16_f32 v25, v26, v27
buffer_store_dwordx2 v[24:25], v22, s[20:23], s55 offen sc1
v_pk_mul_f32 v[28:29], v[88:89], v[132:133] op_sel:[0,1] op_sel_hi:[1,1]
v_pk_mul_f32 v[30:31], v[90:91], v[132:133] op_sel:[0,1] op_sel_hi:[1,1]
v_pk_fma_f32 v[28:29], v[40:41], v[132:133], v[28:29] op_sel:[0,0,0] op_sel_hi:[1,0,1] neg_lo:[0,1,0] neg_hi:[0,1,0]
v_pk_fma_f32 v[30:31], v[42:43], v[132:133], v[30:31] op_sel:[0,0,0] op_sel_hi:[1,0,1] neg_lo:[0,1,0] neg_hi:[0,1,0]
v_cvt_pk_bf16_f32 v28, v28, v29
v_cvt_pk_bf16_f32 v29, v30, v31
buffer_store_dwordx2 v[28:29], v23, s[20:23], s55 offen sc1
s_add_u32 s55, s51, 98304
v_pk_mul_f32 v[8:9], v[76:77], v[128:129] op_sel:[0,1] op_sel_hi:[1,1]
v_pk_mul_f32 v[10:11], v[78:79], v[128:129] op_sel:[0,1] op_sel_hi:[1,1]
v_pk_fma_f32 v[8:9], v[44:45], v[128:129], v[8:9] op_sel:[0,0,0] op_sel_hi:[1,0,1] neg_lo:[0,1,0] neg_hi:[0,1,0]
v_pk_fma_f32 v[10:11], v[46:47], v[128:129], v[10:11] op_sel:[0,0,0] op_sel_hi:[1,0,1] neg_lo:[0,1,0] neg_hi:[0,1,0]
v_cvt_pk_bf16_f32 v8, v8, v9
v_cvt_pk_bf16_f32 v9, v10, v11
buffer_store_dwordx2 v[8:9], v22, s[20:23], s55 offen sc1
v_pk_mul_f32 v[12:13], v[92:93], v[132:133] op_sel:[0,1] op_sel_hi:[1,1]
v_pk_mul_f32 v[14:15], v[94:95], v[132:133] op_sel:[0,1] op_sel_hi:[1,1]
v_pk_fma_f32 v[12:13], v[44:45], v[132:133], v[12:13] op_sel:[0,0,0] op_sel_hi:[1,0,1] neg_lo:[0,1,0] neg_hi:[0,1,0]
v_pk_fma_f32 v[14:15], v[46:47], v[132:133], v[14:15] op_sel:[0,0,0] op_sel_hi:[1,0,1] neg_lo:[0,1,0] neg_hi:[0,1,0]
v_cvt_pk_bf16_f32 v12, v12, v13
v_cvt_pk_bf16_f32 v13, v14, v15
buffer_store_dwordx2 v[12:13], v23, s[20:23], s55 offen sc1
s_add_u32 s55, s52, 0
v_pk_mul_f32 v[24:25], v[96:97], v[128:129] op_sel:[0,1] op_sel_hi:[1,1]
v_pk_mul_f32 v[26:27], v[98:99], v[128:129] op_sel:[0,1] op_sel_hi:[1,1]
v_pk_fma_f32 v[24:25], v[48:49], v[128:129], v[24:25] op_sel:[0,0,0] op_sel_hi:[1,0,1] neg_lo:[0,1,0] neg_hi:[0,1,0]
v_pk_fma_f32 v[26:27], v[50:51], v[128:129], v[26:27] op_sel:[0,0,0] op_sel_hi:[1,0,1] neg_lo:[0,1,0] neg_hi:[0,1,0]
v_cvt_pk_bf16_f32 v24, v24, v25
v_cvt_pk_bf16_f32 v25, v26, v27
buffer_store_dwordx2 v[24:25], v22, s[20:23], s55 offen sc1
v_pk_mul_f32 v[28:29], v[112:113], v[132:133] op_sel:[0,1] op_sel_hi:[1,1]
v_pk_mul_f32 v[30:31], v[114:115], v[132:133] op_sel:[0,1] op_sel_hi:[1,1]
v_pk_fma_f32 v[28:29], v[48:49], v[132:133], v[28:29] op_sel:[0,0,0] op_sel_hi:[1,0,1] neg_lo:[0,1,0] neg_hi:[0,1,0]
v_pk_fma_f32 v[30:31], v[50:51], v[132:133], v[30:31] op_sel:[0,0,0] op_sel_hi:[1,0,1] neg_lo:[0,1,0] neg_hi:[0,1,0]
v_cvt_pk_bf16_f32 v28, v28, v29
v_cvt_pk_bf16_f32 v29, v30, v31
buffer_store_dwordx2 v[28:29], v23, s[20:23], s55 offen sc1
s_add_u32 s55, s52, 32768
v_pk_mul_f32 v[8:9], v[100:101], v[128:129] op_sel:[0,1] op_sel_hi:[1,1]
v_pk_mul_f32 v[10:11], v[102:103], v[128:129] op_sel:[0,1] op_sel_hi:[1,1]
v_pk_fma_f32 v[8:9], v[52:53], v[128:129], v[8:9] op_sel:[0,0,0] op_sel_hi:[1,0,1] neg_lo:[0,1,0] neg_hi:[0,1,0]
v_pk_fma_f32 v[10:11], v[54:55], v[128:129], v[10:11] op_sel:[0,0,0] op_sel_hi:[1,0,1] neg_lo:[0,1,0] neg_hi:[0,1,0]
v_cvt_pk_bf16_f32 v8, v8, v9
v_cvt_pk_bf16_f32 v9, v10, v11
buffer_store_dwordx2 v[8:9], v22, s[20:23], s55 offen sc1
v_pk_mul_f32 v[12:13], v[116:117], v[132:133] op_sel:[0,1] op_sel_hi:[1,1]
v_pk_mul_f32 v[14:15], v[118:119], v[132:133] op_sel:[0,1] op_sel_hi:[1,1]
v_pk_fma_f32 v[12:13], v[52:53], v[132:133], v[12:13] op_sel:[0,0,0] op_sel_hi:[1,0,1] neg_lo:[0,1,0] neg_hi:[0,1,0]
v_pk_fma_f32 v[14:15], v[54:55], v[132:133], v[14:15] op_sel:[0,0,0] op_sel_hi:[1,0,1] neg_lo:[0,1,0] neg_hi:[0,1,0]
v_cvt_pk_bf16_f32 v12, v12, v13
v_cvt_pk_bf16_f32 v13, v14, v15
buffer_store_dwordx2 v[12:13], v23, s[20:23], s55 offen sc1
s_add_u32 s55, s52, 65536
v_pk_mul_f32 v[24:25], v[104:105], v[128:129] op_sel:[0,1] op_sel_hi:[1,1]
v_pk_mul_f32 v[26:27], v[106:107], v[128:129] op_sel:[0,1] op_sel_hi:[1,1]
v_pk_fma_f32 v[24:25], v[56:57], v[128:129], v[24:25] op_sel:[0,0,0] op_sel_hi:[1,0,1] neg_lo:[0,1,0] neg_hi:[0,1,0]
v_pk_fma_f32 v[26:27], v[58:59], v[128:129], v[26:27] op_sel:[0,0,0] op_sel_hi:[1,0,1] neg_lo:[0,1,0] neg_hi:[0,1,0]
v_cvt_pk_bf16_f32 v24, v24, v25
v_cvt_pk_bf16_f32 v25, v26, v27
buffer_store_dwordx2 v[24:25], v22, s[20:23], s55 offen sc1
v_pk_mul_f32 v[28:29], v[120:121], v[132:133] op_sel:[0,1] op_sel_hi:[1,1]
v_pk_mul_f32 v[30:31], v[122:123], v[132:133] op_sel:[0,1] op_sel_hi:[1,1]
v_pk_fma_f32 v[28:29], v[56:57], v[132:133], v[28:29] op_sel:[0,0,0] op_sel_hi:[1,0,1] neg_lo:[0,1,0] neg_hi:[0,1,0]
v_pk_fma_f32 v[30:31], v[58:59], v[132:133], v[30:31] op_sel:[0,0,0] op_sel_hi:[1,0,1] neg_lo:[0,1,0] neg_hi:[0,1,0]
v_cvt_pk_bf16_f32 v28, v28, v29
v_cvt_pk_bf16_f32 v29, v30, v31
buffer_store_dwordx2 v[28:29], v23, s[20:23], s55 offen sc1
s_add_u32 s55, s52, 98304
v_pk_mul_f32 v[8:9], v[108:109], v[128:129] op_sel:[0,1] op_sel_hi:[1,1]
v_pk_mul_f32 v[10:11], v[110:111], v[128:129] op_sel:[0,1] op_sel_hi:[1,1]
v_pk_fma_f32 v[8:9], v[60:61], v[128:129], v[8:9] op_sel:[0,0,0] op_sel_hi:[1,0,1] neg_lo:[0,1,0] neg_hi:[0,1,0]
v_pk_fma_f32 v[10:11], v[62:63], v[128:129], v[10:11] op_sel:[0,0,0] op_sel_hi:[1,0,1] neg_lo:[0,1,0] neg_hi:[0,1,0]
v_cvt_pk_bf16_f32 v8, v8, v9
v_cvt_pk_bf16_f32 v9, v10, v11
buffer_store_dwordx2 v[8:9], v22, s[20:23], s55 offen sc1
v_pk_mul_f32 v[12:13], v[124:125], v[132:133] op_sel:[0,1] op_sel_hi:[1,1]
v_pk_mul_f32 v[14:15], v[126:127], v[132:133] op_sel:[0,1] op_sel_hi:[1,1]
v_pk_fma_f32 v[12:13], v[60:61], v[132:133], v[12:13] op_sel:[0,0,0] op_sel_hi:[1,0,1] neg_lo:[0,1,0] neg_hi:[0,1,0]
v_pk_fma_f32 v[14:15], v[62:63], v[132:133], v[14:15] op_sel:[0,0,0] op_sel_hi:[1,0,1] neg_lo:[0,1,0] neg_hi:[0,1,0]
v_cvt_pk_bf16_f32 v12, v12, v13
v_cvt_pk_bf16_f32 v13, v14, v15
buffer_store_dwordx2 v[12:13], v23, s[20:23], s55 offen sc1
s_waitcnt vmcnt(0)
s_barrier
s_branch L_g1_done
L_g1_join:
s_barrier

s_mov_b32 s96, s31
s_mov_b32 s97, s32
s_cmp_ge_u32 s29, 28
s_cselect_b32 s31, 1, 0
s_cbranch_scc1 L_att_pairL
s_and_b32 s32, s29, 3
s_lshl_b32 s33, s28, 2
s_add_u32 s32, s32, s33
s_lshr_b32 s33, s29, 2
s_add_u32 s33, s33, 1
s_and_b32 s34, s30, 3
s_lshl_b32 s35, s33, 1
s_sub_u32 s35, s35, 2
s_add_u32 s35, s35, s34
s_mov_b32 s36, s32
s_lshl_b32 s37, s33, 1
s_lshr_b32 s38, s30, 2
s_add_u32 s37, s37, s38
s_mov_b32 s51, s35
s_branch L_att_decL
L_att_pairL:
s_sub_u32 s32, s29, 28
s_lshl_b32 s32, s32, 1
s_lshl_b32 s33, s28, 2
s_add_u32 s32, s32, s33
s_mov_b32 s33, 0
s_and_b32 s34, s30, 3
s_and_b32 s35, s34, 1
s_lshr_b32 s36, s34, 1
s_xor_b32 s37, s35, 1
s_cmp_eq_u32 s36, 0
s_cselect_b32 s35, s37, s35
s_add_u32 s36, s36, s32
s_mov_b32 s51, 0
s_mov_b32 s37, 1
L_att_decL:
v_mov_b32 v4, 0x3f803f80
v_mov_b32 v5, 0x00003f80
v_mov_b32 v6, 0x00003f80
v_mov_b32 v7, 0
v_lshlrev_b32 v3, 3, v0
v_mov_b32 v12, 2304
v_cmp_gt_u32 vcc, v12, v3
v_add_u32 v12, 43328, v3
v_add_u32 v13, 45696, v3
v_and_b32 v24, 15, v2
s_and_saveexec_b64 s[60:61], vcc
ds_write_b64 v12, v[4:5]
ds_write_b64 v13, v[6:7]
s_mov_b64 exec, s[60:61]
v_lshlrev_b32 v24, 2, v24
v_lshrrev_b32 v25, 4, v2
s_lshl_b32 s51, s33, 1
s_sub_u32 s51, s51, 2
s_cmp_eq_u32 s31, 0
s_cselect_b32 s51, s51, 0
s_cselect_b32 s37, 3, 1
v_and_b32 v25, s37, v25
v_add_u32 v25, s51, v25
v_lshlrev_b32 v25, 7, v25
v_and_b32 v3, 31, v2
v_lshrrev_b32 v4, 5, v2
v_add_u32 v24, v24, v25
v_lshlrev_b32 v5, 3, v4
v_sub_u32 v5, v3, v5
v_mov_b32 v6, 0xf149f2ca

v_cmp_le_i32 vcc, 0, v5
v_cmp_le_i32 s[56:57], 1, v5
s_nop 0
v_cndmask_b32_e64 v120, v6, 0, vcc
v_cndmask_b32_e64 v136, 0, v6, vcc
v_cndmask_b32_e64 v121, v6, 0, s[56:57]
v_cndmask_b32_e64 v137, 0, v6, s[56:57]
v_cmp_le_i32 vcc, 2, v5
v_cmp_le_i32 s[56:57], 3, v5
s_nop 0
v_cndmask_b32_e64 v122, v6, 0, vcc
v_cndmask_b32_e64 v138, 0, v6, vcc
v_cndmask_b32_e64 v123, v6, 0, s[56:57]
v_cndmask_b32_e64 v139, 0, v6, s[56:57]
v_cmp_le_i32 vcc, 4, v5
v_cmp_le_i32 s[56:57], 5, v5
s_nop 0
v_cndmask_b32_e64 v124, v6, 0, vcc
v_cndmask_b32_e64 v140, 0, v6, vcc
v_cndmask_b32_e64 v125, v6, 0, s[56:57]
v_cndmask_b32_e64 v141, 0, v6, s[56:57]
v_cmp_le_i32 vcc, 6, v5
v_cmp_le_i32 s[56:57], 7, v5
s_nop 0
v_cndmask_b32_e64 v126, v6, 0, vcc
v_cndmask_b32_e64 v142, 0, v6, vcc
v_cndmask_b32_e64 v127, v6, 0, s[56:57]
v_cndmask_b32_e64 v143, 0, v6, s[56:57]
v_cmp_le_i32 vcc, 16, v5
v_cmp_le_i32 s[56:57], 17, v5
s_nop 0
v_cndmask_b32_e64 v128, v6, 0, vcc
v_cndmask_b32_e64 v144, 0, v6, vcc
v_cndmask_b32_e64 v129, v6, 0, s[56:57]
v_cndmask_b32_e64 v145, 0, v6, s[56:57]
v_cmp_le_i32 vcc, 18, v5
v_cmp_le_i32 s[56:57], 19, v5
s_nop 0
v_cndmask_b32_e64 v130, v6, 0, vcc
v_cndmask_b32_e64 v146, 0, v6, vcc
v_cndmask_b32_e64 v131, v6, 0, s[56:57]
v_cndmask_b32_e64 v147, 0, v6, s[56:57]
v_cmp_le_i32 vcc, 20, v5
v_cmp_le_i32 s[56:57], 21, v5
s_nop 0
v_cndmask_b32_e64 v132, v6, 0, vcc
v_cndmask_b32_e64 v148, 0, v6, vcc
v_cndmask_b32_e64 v133, v6, 0, s[56:57]
v_cndmask_b32_e64 v149, 0, v6, s[56:57]
v_cmp_le_i32 vcc, 22, v5
v_cmp_le_i32 s[56:57], 23, v5
s_nop 0
v_cndmask_b32_e64 v134, v6, 0, vcc
v_cndmask_b32_e64 v150, 0, v6, vcc
v_cndmask_b32_e64 v135, v6, 0, s[56:57]
v_cndmask_b32_e64 v151, 0, v6, s[56:57]

v_and_b32 v5, 19, v3
v_and_b32 v6, 4, v3
v_lshlrev_b32 v6, 1, v6
v_or_b32 v5, v5, v6
v_and_b32 v6, 8, v3
v_lshrrev_b32 v6, 1, v6
v_or_b32 v5, v5, v6
v_lshlrev_b32 v5, 3, v5
v_mul_u32_u24 v6, 8256, v4
v_add_u32 v14, v5, v6
v_add_u32 v14, 2048, v14
v_add_u32 v15, 18560, v5
v_lshrrev_b32 v5, 4, v2
v_and_b32 v6, 1, v5
v_bfe_u32 v7, v2, 2, 2
v_and_b32 v12, 3, v2
v_lshlrev_b32 v13, 3, v4
v_add_u32 v13, v13, v7
v_lshlrev_b32 v13, 3, v13
v_lshlrev_b32 v16, 2, v6
v_add_u32 v16, v16, v12
v_mul_u32_u24 v17, 4128, v16
v_add_u32 v17, v17, v13
v_add_u32 v17, 22688, v17
v_cmp_lt_u32 s[60:61], 4, v16
v_cmp_eq_u32 s[62:63], 1, v4
s_mul_i32 s44, s32, 20
s_mul_i32 s45, s31, 20
s_add_u32 s45, s45, s44
s_add_u32 s45, s45, 19
s_lshr_b32 s46, s44, 7
s_lshr_b32 s47, s45, 7
s_bfm_b32 s74, 1, s46
s_bfm_b32 s75, 1, s47
s_or_b32 s74, s74, s75
s_add_u32 s46, s44, 640
s_add_u32 s47, s45, 640
s_lshr_b32 s46, s46, 7
s_lshr_b32 s47, s47, 7
s_bfm_b32 s75, 1, s46
s_bfm_b32 s76, 1, s47
s_or_b32 s75, s75, s76
s_add_u32 s46, s44, 1280
s_add_u32 s47, s45, 1280
s_lshr_b32 s46, s46, 7
s_lshr_b32 s47, s47, 7
s_bfm_b32 s76, 1, s46
s_or_b32 s75, s75, s76
s_bfm_b32 s76, 1, s47
s_or_b32 s75, s75, s76
s_or_b32 s74, s74, s75
s_lshl_b32 s76, s74, 16
s_or_b32 s77, s76, s74
s_lshl_b32 s76, s75, 16
s_or_b32 s76, s76, s75
s_cmp_eq_u32 s31, 0
s_cselect_b32 s76, s76, s77
s_lshr_b32 s38, s30, 2
s_lshl_b32 s39, s38, 5
s_add_u32 s39, s39, 32
s_add_u32 s39, s39, s36
s_mul_i32 s39, s39, 81920
s_lshl_b32 s40, s35, 10
s_add_u32 s92, s39, s40
s_mul_i32 s40, s38, 20640
s_lshl_b32 s41, s34, 10
s_add_u32 s40, s40, s41
s_add_u32 s93, s40, 2048
v_lshlrev_b32 v27, 4, v2
s_cmp_eq_u32 s31, 0
s_cbranch_scc1 L_att_sdL

v_mov_b32 v136, v120
v_mov_b32 v137, v121
v_mov_b32 v138, v122
v_mov_b32 v139, v123
v_mov_b32 v140, v124
v_mov_b32 v141, v125
v_mov_b32 v142, v126
v_mov_b32 v143, v127
v_mov_b32 v144, v128
v_mov_b32 v145, v129
v_mov_b32 v146, v130
v_mov_b32 v147, v131
v_mov_b32 v148, v132
v_mov_b32 v149, v133
v_mov_b32 v150, v134
v_mov_b32 v151, v135
s_cmp_lt_u32 s34, 2
s_cbranch_scc0 L_att_sdL
v_xor_b32 v27, 0x300, v27
L_att_sdL:
s_waitcnt lgkmcnt(0)
s_barrier
s_cmp_lg_u32 s30, 4
s_cbranch_scc1 L_g1_l_done
s_lshl_b32 s40, s96, 7
s_lshl_b32 s41, s97, 2
s_add_u32 s40, s40, s41
s_add_u32 s40, s40, 11862016
v_mov_b32 v13, s26
s_mov_b64 exec, 1
buffer_store_dword v13, off, s[20:23], s40 sc1
s_mov_b64 exec, -1
L_g1_l_done:
s_branch L_g1_after
L_g1_done:
v_mov_b32 v20, 154624
ds_read_b128 v[16:19], v20
s_waitcnt lgkmcnt(0)
v_readfirstlane_b32 s70, v16
v_readfirstlane_b32 s71, v17
v_readfirstlane_b32 s72, v18
v_readfirstlane_b32 s73, v19

s_mov_b32 s96, s31
s_mov_b32 s97, s32
s_cmp_ge_u32 s29, 28
s_cselect_b32 s31, 1, 0
s_cbranch_scc1 L_att_pairC
s_and_b32 s32, s29, 3
s_lshl_b32 s33, s28, 2
s_add_u32 s32, s32, s33
s_lshr_b32 s33, s29, 2
s_add_u32 s33, s33, 1
s_and_b32 s34, s30, 3
s_lshl_b32 s35, s33, 1
s_sub_u32 s35, s35, 2
s_add_u32 s35, s35, s34
s_mov_b32 s36, s32
s_lshl_b32 s37, s33, 1
s_lshr_b32 s38, s30, 2
s_add_u32 s37, s37, s38
s_mov_b32 s51, s35
s_branch L_att_decC
L_att_pairC:
s_sub_u32 s32, s29, 28
s_lshl_b32 s32, s32, 1
s_lshl_b32 s33, s28, 2
s_add_u32 s32, s32, s33
s_mov_b32 s33, 0
s_and_b32 s34, s30, 3
s_and_b32 s35, s34, 1
s_lshr_b32 s36, s34, 1
s_xor_b32 s37, s35, 1
s_cmp_eq_u32 s36, 0
s_cselect_b32 s35, s37, s35
s_add_u32 s36, s36, s32
s_mov_b32 s51, 0
s_mov_b32 s37, 1
L_att_decC:
v_mov_b32 v4, 0x3f803f80
v_mov_b32 v5, 0x00003f80
v_mov_b32 v6, 0x00003f80
v_mov_b32 v7, 0
v_lshlrev_b32 v3, 3, v0
v_mov_b32 v12, 2304
v_cmp_gt_u32 vcc, v12, v3
v_add_u32 v12, 43328, v3
v_add_u32 v13, 45696, v3
v_and_b32 v24, 15, v2
s_and_saveexec_b64 s[60:61], vcc
ds_write_b64 v12, v[4:5]
ds_write_b64 v13, v[6:7]
s_mov_b64 exec, s[60:61]
v_lshlrev_b32 v24, 2, v24
v_lshrrev_b32 v25, 4, v2
s_lshl_b32 s51, s33, 1
s_sub_u32 s51, s51, 2
s_cmp_eq_u32 s31, 0
s_cselect_b32 s51, s51, 0
s_cselect_b32 s37, 3, 1
v_and_b32 v25, s37, v25
v_add_u32 v25, s51, v25
v_lshlrev_b32 v25, 7, v25
v_and_b32 v3, 31, v2
v_lshrrev_b32 v4, 5, v2
v_add_u32 v24, v24, v25
v_lshlrev_b32 v5, 3, v4
v_sub_u32 v5, v3, v5
v_mov_b32 v6, 0xf149f2ca

v_cmp_le_i32 vcc, 0, v5
v_cmp_le_i32 s[56:57], 1, v5
s_nop 0
v_cndmask_b32_e64 v120, v6, 0, vcc
v_cndmask_b32_e64 v136, 0, v6, vcc
v_cndmask_b32_e64 v121, v6, 0, s[56:57]
v_cndmask_b32_e64 v137, 0, v6, s[56:57]
v_cmp_le_i32 vcc, 2, v5
v_cmp_le_i32 s[56:57], 3, v5
s_nop 0
v_cndmask_b32_e64 v122, v6, 0, vcc
v_cndmask_b32_e64 v138, 0, v6, vcc
v_cndmask_b32_e64 v123, v6, 0, s[56:57]
v_cndmask_b32_e64 v139, 0, v6, s[56:57]
v_cmp_le_i32 vcc, 4, v5
v_cmp_le_i32 s[56:57], 5, v5
s_nop 0
v_cndmask_b32_e64 v124, v6, 0, vcc
v_cndmask_b32_e64 v140, 0, v6, vcc
v_cndmask_b32_e64 v125, v6, 0, s[56:57]
v_cndmask_b32_e64 v141, 0, v6, s[56:57]
v_cmp_le_i32 vcc, 6, v5
v_cmp_le_i32 s[56:57], 7, v5
s_nop 0
v_cndmask_b32_e64 v126, v6, 0, vcc
v_cndmask_b32_e64 v142, 0, v6, vcc
v_cndmask_b32_e64 v127, v6, 0, s[56:57]
v_cndmask_b32_e64 v143, 0, v6, s[56:57]
v_cmp_le_i32 vcc, 16, v5
v_cmp_le_i32 s[56:57], 17, v5
s_nop 0
v_cndmask_b32_e64 v128, v6, 0, vcc
v_cndmask_b32_e64 v144, 0, v6, vcc
v_cndmask_b32_e64 v129, v6, 0, s[56:57]
v_cndmask_b32_e64 v145, 0, v6, s[56:57]
v_cmp_le_i32 vcc, 18, v5
v_cmp_le_i32 s[56:57], 19, v5
s_nop 0
v_cndmask_b32_e64 v130, v6, 0, vcc
v_cndmask_b32_e64 v146, 0, v6, vcc
v_cndmask_b32_e64 v131, v6, 0, s[56:57]
v_cndmask_b32_e64 v147, 0, v6, s[56:57]
v_cmp_le_i32 vcc, 20, v5
v_cmp_le_i32 s[56:57], 21, v5
s_nop 0
v_cndmask_b32_e64 v132, v6, 0, vcc
v_cndmask_b32_e64 v148, 0, v6, vcc
v_cndmask_b32_e64 v133, v6, 0, s[56:57]
v_cndmask_b32_e64 v149, 0, v6, s[56:57]
v_cmp_le_i32 vcc, 22, v5
v_cmp_le_i32 s[56:57], 23, v5
s_nop 0
v_cndmask_b32_e64 v134, v6, 0, vcc
v_cndmask_b32_e64 v150, 0, v6, vcc
v_cndmask_b32_e64 v135, v6, 0, s[56:57]
v_cndmask_b32_e64 v151, 0, v6, s[56:57]

v_and_b32 v5, 19, v3
v_and_b32 v6, 4, v3
v_lshlrev_b32 v6, 1, v6
v_or_b32 v5, v5, v6
v_and_b32 v6, 8, v3
v_lshrrev_b32 v6, 1, v6
v_or_b32 v5, v5, v6
v_lshlrev_b32 v5, 3, v5
v_mul_u32_u24 v6, 8256, v4
v_add_u32 v14, v5, v6
v_add_u32 v14, 2048, v14
v_add_u32 v15, 18560, v5
v_lshrrev_b32 v5, 4, v2
v_and_b32 v6, 1, v5
v_bfe_u32 v7, v2, 2, 2
v_and_b32 v12, 3, v2
v_lshlrev_b32 v13, 3, v4
v_add_u32 v13, v13, v7
v_lshlrev_b32 v13, 3, v13
v_lshlrev_b32 v16, 2, v6
v_add_u32 v16, v16, v12
v_mul_u32_u24 v17, 4128, v16
v_add_u32 v17, v17, v13
v_add_u32 v17, 22688, v17
v_cmp_lt_u32 s[60:61], 4, v16
v_cmp_eq_u32 s[62:63], 1, v4
s_mul_i32 s44, s32, 20
s_mul_i32 s45, s31, 20
s_add_u32 s45, s45, s44
s_add_u32 s45, s45, 19
s_lshr_b32 s46, s44, 7
s_lshr_b32 s47, s45, 7
s_bfm_b32 s74, 1, s46
s_bfm_b32 s75, 1, s47
s_or_b32 s74, s74, s75
s_add_u32 s46, s44, 640
s_add_u32 s47, s45, 640
s_lshr_b32 s46, s46, 7
s_lshr_b32 s47, s47, 7
s_bfm_b32 s75, 1, s46
s_bfm_b32 s76, 1, s47
s_or_b32 s75, s75, s76
s_add_u32 s46, s44, 1280
s_add_u32 s47, s45, 1280
s_lshr_b32 s46, s46, 7
s_lshr_b32 s47, s47, 7
s_bfm_b32 s76, 1, s46
s_or_b32 s75, s75, s76
s_bfm_b32 s76, 1, s47
s_or_b32 s75, s75, s76
s_or_b32 s74, s74, s75
s_lshl_b32 s76, s74, 16
s_or_b32 s77, s76, s74
s_lshl_b32 s76, s75, 16
s_or_b32 s76, s76, s75
s_cmp_eq_u32 s31, 0
s_cselect_b32 s76, s76, s77
s_lshr_b32 s38, s30, 2
s_lshl_b32 s39, s38, 5
s_add_u32 s39, s39, 32
s_add_u32 s39, s39, s36
s_mul_i32 s39, s39, 81920
s_lshl_b32 s40, s35, 10
s_add_u32 s92, s39, s40
s_mul_i32 s40, s38, 20640
s_lshl_b32 s41, s34, 10
s_add_u32 s40, s40, s41
s_add_u32 s93, s40, 2048
v_lshlrev_b32 v27, 4, v2
s_cmp_eq_u32 s31, 0
s_cbranch_scc1 L_att_sdC

v_mov_b32 v136, v120
v_mov_b32 v137, v121
v_mov_b32 v138, v122
v_mov_b32 v139, v123
v_mov_b32 v140, v124
v_mov_b32 v141, v125
v_mov_b32 v142, v126
v_mov_b32 v143, v127
v_mov_b32 v144, v128
v_mov_b32 v145, v129
v_mov_b32 v146, v130
v_mov_b32 v147, v131
v_mov_b32 v148, v132
v_mov_b32 v149, v133
v_mov_b32 v150, v134
v_mov_b32 v151, v135
s_cmp_lt_u32 s34, 2
s_cbranch_scc0 L_att_sdC
v_xor_b32 v27, 0x300, v27
L_att_sdC:
L_g1_after:
s_lshl_b32 s98, s28, 2
s_lshr_b32 s99, s29, 3
s_add_u32 s98, s98, s99
s_and_b32 s99, s29, 7
s_mov_b32 s94, 429496730
v_add_u32 v206, 0, v0
v_mul_hi_u32 v207, v206, s94
v_mul_u32_u24 v208, 10, v207
v_sub_u32 v208, v206, v208
v_mul_u32_u24 v209, 336, v207
v_lshlrev_b32 v215, 5, v208
v_add_u32 v204, v209, v215
v_and_b32 v207, 63, v207
s_lshl_b32 s88, s98, 6
v_add_u32 v202, s88, v207
v_mul_u32_u24 v209, 1280, v202
v_lshlrev_b32 v215, 4, v208
v_add_u32 v209, v209, v215
s_mul_i32 s88, s99, 160
v_add_u32 v200, s88, v209
v_lshlrev_b32 v209, 4, v202
s_mov_b32 s88, 11534336
buffer_load_dwordx4 v[184:187], v200, s[4:7], 0 offen
buffer_load_dwordx4 v[192:195], v209, s[20:23], s88 offen sc1
v_add_u32 v206, 512, v0
v_mul_hi_u32 v207, v206, s94
v_mul_u32_u24 v208, 10, v207
v_sub_u32 v208, v206, v208
v_mul_u32_u24 v209, 336, v207
v_lshlrev_b32 v215, 5, v208
v_add_u32 v205, v209, v215
v_and_b32 v207, 63, v207
s_lshl_b32 s88, s98, 6
v_add_u32 v203, s88, v207
v_mul_u32_u24 v209, 1280, v203
v_lshlrev_b32 v215, 4, v208
v_add_u32 v209, v209, v215
s_mul_i32 s88, s99, 160
v_add_u32 v201, s88, v209
v_lshlrev_b32 v209, 4, v203
s_mov_b32 s88, 11534336
buffer_load_dwordx4 v[188:191], v201, s[4:7], 0 offen
buffer_load_dwordx4 v[196:199], v209, s[20:23], s88 offen sc1
v_lshlrev_b32 v168, 5, v2
s_mov_b32 s55, 11796480
buffer_load_dwordx4 v[160:163], v168, s[20:23], s55 offen sc1
buffer_load_dwordx4 v[164:167], v168, s[20:23], s55 offen offset:16 sc1
s_mov_b32 s52, 11862016
s_cmp_eq_u32 s30, 4
s_cbranch_scc0 L_att_nopoll
s_mov_b32 s27, 0x20000
s_mov_b32 s56, s76
s_mov_b32 s57, s77
buffer_load_dword v25, v24, s[20:23], s52 offen sc1
s_sleep 6
L_pf2:
buffer_load_dword v26, v24, s[20:23], s52 offen sc1
s_waitcnt vmcnt(1)
v_cmp_eq_u32 vcc, s26, v25
s_sub_u32 s27, s27, 1
s_nop 3
s_andn2_b64 s[58:59], s[56:57], vcc
s_cmp_eq_u64 s[58:59], 0
s_cbranch_scc1 L_pfd2
buffer_load_dword v25, v24, s[20:23], s52 offen sc1
s_waitcnt vmcnt(1)
v_cmp_eq_u32 vcc, s26, v26
s_nop 4
s_andn2_b64 s[58:59], s[56:57], vcc
s_cmp_eq_u64 s[58:59], 0
s_cbranch_scc1 L_pfd2
s_cmp_lg_u32 s27, 0
s_cbranch_scc1 L_pf2
L_pfd2:
s_branch L_att_pbar
L_att_nopoll:
s_mov_b32 s27, 0x20000

L_xn_chk3:
s_waitcnt vmcnt(0)
L_xn_chk23:
v_cmp_eq_u32 vcc, s26, v195
v_cmp_eq_u32 s[56:57], s26, v199
s_sub_u32 s27, s27, 1
s_nop 3
s_and_b64 vcc, vcc, s[56:57]
s_cmp_eq_u64 vcc, -1
s_cbranch_scc1 L_xn_ok3
s_cmp_eq_u32 s27, 0
s_cbranch_scc1 L_xn_ok3
v_lshlrev_b32 v209, 4, v202
s_mov_b32 s88, 11534336
buffer_load_dwordx4 v[192:195], v209, s[20:23], s88 offen sc1
v_lshlrev_b32 v209, 4, v203
s_mov_b32 s88, 11534336
buffer_load_dwordx4 v[196:199], v209, s[20:23], s88 offen sc1
s_branch L_xn_chk3
L_xn_ok3:
v_lshlrev_b32 v232, 16, v184
v_and_b32 v233, 0xffff0000, v184
v_pk_add_f32 v[216:217], v[232:233], v[192:193] op_sel_hi:[1,0] neg_lo:[0,1] neg_hi:[0,1]
v_cvt_pk_bf16_f32 v216, v216, v217
v_and_b32 v217, 0xffff0000, v216
v_lshlrev_b32 v216, 16, v216
v_pk_mul_f32 v[216:217], v[216:217], v[192:193] op_sel:[0,1] op_sel_hi:[1,1]
v_cvt_pk_bf16_f32 v216, v216, v217
v_and_b32 v217, 0xffff0000, v216
v_lshlrev_b32 v216, 16, v216
v_lshlrev_b32 v234, 16, v185
v_and_b32 v235, 0xffff0000, v185
v_pk_add_f32 v[218:219], v[234:235], v[192:193] op_sel_hi:[1,0] neg_lo:[0,1] neg_hi:[0,1]
v_cvt_pk_bf16_f32 v218, v218, v219
v_and_b32 v219, 0xffff0000, v218
v_lshlrev_b32 v218, 16, v218
v_pk_mul_f32 v[218:219], v[218:219], v[192:193] op_sel:[0,1] op_sel_hi:[1,1]
v_cvt_pk_bf16_f32 v218, v218, v219
v_and_b32 v219, 0xffff0000, v218
v_lshlrev_b32 v218, 16, v218
v_lshlrev_b32 v236, 16, v186
v_and_b32 v237, 0xffff0000, v186
v_pk_add_f32 v[220:221], v[236:237], v[192:193] op_sel_hi:[1,0] neg_lo:[0,1] neg_hi:[0,1]
v_cvt_pk_bf16_f32 v220, v220, v221
v_and_b32 v221, 0xffff0000, v220
v_lshlrev_b32 v220, 16, v220
v_pk_mul_f32 v[220:221], v[220:221], v[192:193] op_sel:[0,1] op_sel_hi:[1,1]
v_cvt_pk_bf16_f32 v220, v220, v221
v_and_b32 v221, 0xffff0000, v220
v_lshlrev_b32 v220, 16, v220
v_lshlrev_b32 v238, 16, v187
v_and_b32 v239, 0xffff0000, v187
v_pk_add_f32 v[222:223], v[238:239], v[192:193] op_sel_hi:[1,0] neg_lo:[0,1] neg_hi:[0,1]
v_cvt_pk_bf16_f32 v222, v222, v223
v_and_b32 v223, 0xffff0000, v222
v_lshlrev_b32 v222, 16, v222
v_pk_mul_f32 v[222:223], v[222:223], v[192:193] op_sel:[0,1] op_sel_hi:[1,1]
v_cvt_pk_bf16_f32 v222, v222, v223
v_and_b32 v223, 0xffff0000, v222
v_lshlrev_b32 v222, 16, v222
v_lshlrev_b32 v240, 16, v188
v_and_b32 v241, 0xffff0000, v188
v_pk_add_f32 v[224:225], v[240:241], v[196:197] op_sel_hi:[1,0] neg_lo:[0,1] neg_hi:[0,1]
v_cvt_pk_bf16_f32 v224, v224, v225
v_and_b32 v225, 0xffff0000, v224
v_lshlrev_b32 v224, 16, v224
v_pk_mul_f32 v[224:225], v[224:225], v[196:197] op_sel:[0,1] op_sel_hi:[1,1]
v_cvt_pk_bf16_f32 v224, v224, v225
v_and_b32 v225, 0xffff0000, v224
v_lshlrev_b32 v224, 16, v224
v_lshlrev_b32 v242, 16, v189
v_and_b32 v243, 0xffff0000, v189
v_pk_add_f32 v[226:227], v[242:243], v[196:197] op_sel_hi:[1,0] neg_lo:[0,1] neg_hi:[0,1]
v_cvt_pk_bf16_f32 v226, v226, v227
v_and_b32 v227, 0xffff0000, v226
v_lshlrev_b32 v226, 16, v226
v_pk_mul_f32 v[226:227], v[226:227], v[196:197] op_sel:[0,1] op_sel_hi:[1,1]
v_cvt_pk_bf16_f32 v226, v226, v227
v_and_b32 v227, 0xffff0000, v226
v_lshlrev_b32 v226, 16, v226
v_lshlrev_b32 v244, 16, v190
v_and_b32 v245, 0xffff0000, v190
v_pk_add_f32 v[228:229], v[244:245], v[196:197] op_sel_hi:[1,0] neg_lo:[0,1] neg_hi:[0,1]
v_cvt_pk_bf16_f32 v228, v228, v229
v_and_b32 v229, 0xffff0000, v228
v_lshlrev_b32 v228, 16, v228
v_pk_mul_f32 v[228:229], v[228:229], v[196:197] op_sel:[0,1] op_sel_hi:[1,1]
v_cvt_pk_bf16_f32 v228, v228, v229
v_and_b32 v229, 0xffff0000, v228
v_lshlrev_b32 v228, 16, v228
v_lshlrev_b32 v246, 16, v191
v_and_b32 v247, 0xffff0000, v191
v_pk_add_f32 v[230:231], v[246:247], v[196:197] op_sel_hi:[1,0] neg_lo:[0,1] neg_hi:[0,1]
v_cvt_pk_bf16_f32 v230, v230, v231
v_and_b32 v231, 0xffff0000, v230
v_lshlrev_b32 v230, 16, v230
v_pk_mul_f32 v[230:231], v[230:231], v[196:197] op_sel:[0,1] op_sel_hi:[1,1]
v_cvt_pk_bf16_f32 v230, v230, v231
v_and_b32 v231, 0xffff0000, v230
v_lshlrev_b32 v230, 16, v230
s_mov_b32 s27, 0x20000

L_gt4:
v_cmp_eq_u32 vcc, s26, v162
v_cmp_eq_u32 s[56:57], s26, v166
s_sub_u32 s27, s27, 1
s_nop 3
s_and_b64 vcc, vcc, s[56:57]
s_cmp_eq_u64 vcc, -1
s_cbranch_scc1 L_gtd4
s_cmp_eq_u32 s27, 0
s_cbranch_scc1 L_gtd4
s_sleep 2
v_lshlrev_b32 v168, 5, v2
s_mov_b32 s55, 11796480
buffer_load_dwordx4 v[160:163], v168, s[20:23], s55 offen sc1
buffer_load_dwordx4 v[164:167], v168, s[20:23], s55 offen offset:16 sc1
s_waitcnt vmcnt(0)
s_branch L_gt4
L_gtd4:
v_max_u32 v169, v160, v164
s_nop 1
v_max_u32_dpp v169, v169, v169 row_shr:1 row_mask:0xf bank_mask:0xf bound_ctrl:0
s_nop 1
v_max_u32_dpp v169, v169, v169 row_shr:2 row_mask:0xf bank_mask:0xf bound_ctrl:0
s_nop 1
v_max_u32_dpp v169, v169, v169 row_shr:4 row_mask:0xf bank_mask:0xf bound_ctrl:0
s_nop 1
v_max_u32_dpp v169, v169, v169 row_shr:8 row_mask:0xf bank_mask:0xf bound_ctrl:0
s_nop 1
v_max_u32_dpp v169, v169, v169 row_bcast:15 row_mask:0xa bank_mask:0xf
s_nop 1
v_max_u32_dpp v169, v169, v169 row_bcast:31 row_mask:0xc bank_mask:0xf
s_nop 1
v_readlane_b32 s72, v169, 63
s_nop 3
v_cmp_ne_u32 vcc, s72, v160
v_cmp_ne_u32 s[56:57], s72, v164
s_nop 0
v_cndmask_b32 v160, v161, v160, vcc
v_cndmask_b32 v164, v165, v164, s[56:57]
v_max_u32 v169, v160, v164
s_nop 1
v_max_u32_dpp v169, v169, v169 row_shr:1 row_mask:0xf bank_mask:0xf bound_ctrl:0
s_nop 1
v_max_u32_dpp v169, v169, v169 row_shr:2 row_mask:0xf bank_mask:0xf bound_ctrl:0
s_nop 1
v_max_u32_dpp v169, v169, v169 row_shr:4 row_mask:0xf bank_mask:0xf bound_ctrl:0
s_nop 1
v_max_u32_dpp v169, v169, v169 row_shr:8 row_mask:0xf bank_mask:0xf bound_ctrl:0
s_nop 1
v_max_u32_dpp v169, v169, v169 row_bcast:15 row_mask:0xa bank_mask:0xf
s_nop 1
v_max_u32_dpp v169, v169, v169 row_bcast:31 row_mask:0xc bank_mask:0xf
s_nop 1
v_readlane_b32 s73, v169, 63
s_and_b32 s70, s72, 0x7ff
s_sub_u32 s70, 2047, s70
s_nop 2
s_and_b32 s71, s73, 0x7ff
s_sub_u32 s71, 2047, s71
L_att_pbar:
s_barrier
s_cmp_ge_u32 s30, 4
s_cbranch_scc0 L_att_noprio
s_setprio 1
L_att_noprio:
s_add_u32 m0, s93, 0
s_add_u32 s53, s92, 0
buffer_load_dwordx4 v27, s[20:23], s53 offen sc1 lds
s_add_u32 m0, s93, 4128
s_add_u32 s53, s92, 16384
buffer_load_dwordx4 v27, s[20:23], s53 offen sc1 lds
s_add_u32 m0, s93, 8256
s_add_u32 s53, s92, 32768
buffer_load_dwordx4 v27, s[20:23], s53 offen sc1 lds
s_add_u32 m0, s93, 12384
s_add_u32 s53, s92, 49152
buffer_load_dwordx4 v27, s[20:23], s53 offen sc1 lds
s_add_u32 m0, s93, 16512
s_add_u32 s53, s92, 65536
buffer_load_dwordx4 v27, s[20:23], s53 offen sc1 lds
s_cmp_eq_u32 s31, 0
s_cbranch_scc0 L_ap_p5
s_mov_b32 s41, s30
s_mov_b32 s42, s32
s_lshl_b32 s43, s33, 8
s_lshl_b32 s44, s30, 5
s_add_u32 s43, s43, s44
s_mov_b32 s49, 15
s_branch L_ap_go5
L_ap_p5:
s_sub_u32 s41, 7, s30
s_mov_b32 s42, s32
s_lshl_b32 s43, s30, 5
s_add_u32 s53, s32, 1
s_lshl_b32 s54, s41, 5
s_add_u32 s49, s30, 1
L_ap_go5:
v_add_u32 v18, s43, v3
v_lshlrev_b32 v18, 3, v18
v_lshlrev_b32 v19, 15, v4
v_add_u32 v19, v19, v18
s_mul_i32 s45, s42, 81920
buffer_load_dwordx2 v[32:33], v19, s[20:23], s45 offen sc1
s_add_u32 s46, s45, 16384
buffer_load_dwordx2 v[34:35], v19, s[20:23], s46 offen sc1
s_add_u32 s46, s45, 65536
buffer_load_dwordx2 v[36:37], v18, s[20:23], s46 offen sc1
s_cmp_eq_u32 s31, 0
s_cbranch_scc1 L_att_noq2
v_add_u32 v18, s54, v3
v_lshlrev_b32 v18, 3, v18
v_lshlrev_b32 v19, 15, v4
v_add_u32 v19, v19, v18
s_mul_i32 s45, s53, 81920
buffer_load_dwordx2 v[152:153], v19, s[20:23], s45 offen sc1
s_add_u32 s46, s45, 16384
buffer_load_dwordx2 v[154:155], v19, s[20:23], s46 offen sc1
s_add_u32 s46, s45, 65536
buffer_load_dwordx2 v[156:157], v18, s[20:23], s46 offen sc1
L_att_noq2:
s_mov_b32 s78, s53
s_mov_b32 s79, s54
s_cmp_eq_u32 s30, 4
s_cbranch_scc0 L_att_hx
s_mov_b32 s27, 0x20000
s_branch L_xn_chk26
L_xn_chk6:
s_waitcnt vmcnt(0)
L_xn_chk26:
v_cmp_eq_u32 vcc, s26, v195
v_cmp_eq_u32 s[56:57], s26, v199
s_sub_u32 s27, s27, 1
s_nop 3
s_and_b64 vcc, vcc, s[56:57]
s_cmp_eq_u64 vcc, -1
s_cbranch_scc1 L_xn_ok6
s_cmp_eq_u32 s27, 0
s_cbranch_scc1 L_xn_ok6
v_lshlrev_b32 v209, 4, v202
s_mov_b32 s88, 11534336
buffer_load_dwordx4 v[192:195], v209, s[20:23], s88 offen sc1
v_lshlrev_b32 v209, 4, v203
s_mov_b32 s88, 11534336
buffer_load_dwordx4 v[196:199], v209, s[20:23], s88 offen sc1
s_branch L_xn_chk6
L_xn_ok6:
v_lshlrev_b32 v232, 16, v184
v_and_b32 v233, 0xffff0000, v184
v_pk_add_f32 v[216:217], v[232:233], v[192:193] op_sel_hi:[1,0] neg_lo:[0,1] neg_hi:[0,1]
v_cvt_pk_bf16_f32 v216, v216, v217
v_and_b32 v217, 0xffff0000, v216
v_lshlrev_b32 v216, 16, v216
v_pk_mul_f32 v[216:217], v[216:217], v[192:193] op_sel:[0,1] op_sel_hi:[1,1]
v_cvt_pk_bf16_f32 v216, v216, v217
v_and_b32 v217, 0xffff0000, v216
v_lshlrev_b32 v216, 16, v216
v_lshlrev_b32 v234, 16, v185
v_and_b32 v235, 0xffff0000, v185
v_pk_add_f32 v[218:219], v[234:235], v[192:193] op_sel_hi:[1,0] neg_lo:[0,1] neg_hi:[0,1]
v_cvt_pk_bf16_f32 v218, v218, v219
v_and_b32 v219, 0xffff0000, v218
v_lshlrev_b32 v218, 16, v218
v_pk_mul_f32 v[218:219], v[218:219], v[192:193] op_sel:[0,1] op_sel_hi:[1,1]
v_cvt_pk_bf16_f32 v218, v218, v219
v_and_b32 v219, 0xffff0000, v218
v_lshlrev_b32 v218, 16, v218
v_lshlrev_b32 v236, 16, v186
v_and_b32 v237, 0xffff0000, v186
v_pk_add_f32 v[220:221], v[236:237], v[192:193] op_sel_hi:[1,0] neg_lo:[0,1] neg_hi:[0,1]
v_cvt_pk_bf16_f32 v220, v220, v221
v_and_b32 v221, 0xffff0000, v220
v_lshlrev_b32 v220, 16, v220
v_pk_mul_f32 v[220:221], v[220:221], v[192:193] op_sel:[0,1] op_sel_hi:[1,1]
v_cvt_pk_bf16_f32 v220, v220, v221
v_and_b32 v221, 0xffff0000, v220
v_lshlrev_b32 v220, 16, v220
v_lshlrev_b32 v238, 16, v187
v_and_b32 v239, 0xffff0000, v187
v_pk_add_f32 v[222:223], v[238:239], v[192:193] op_sel_hi:[1,0] neg_lo:[0,1] neg_hi:[0,1]
v_cvt_pk_bf16_f32 v222, v222, v223
v_and_b32 v223, 0xffff0000, v222
v_lshlrev_b32 v222, 16, v222
v_pk_mul_f32 v[222:223], v[222:223], v[192:193] op_sel:[0,1] op_sel_hi:[1,1]
v_cvt_pk_bf16_f32 v222, v222, v223
v_and_b32 v223, 0xffff0000, v222
v_lshlrev_b32 v222, 16, v222
v_lshlrev_b32 v240, 16, v188
v_and_b32 v241, 0xffff0000, v188
v_pk_add_f32 v[224:225], v[240:241], v[196:197] op_sel_hi:[1,0] neg_lo:[0,1] neg_hi:[0,1]
v_cvt_pk_bf16_f32 v224, v224, v225
v_and_b32 v225, 0xffff0000, v224
v_lshlrev_b32 v224, 16, v224
v_pk_mul_f32 v[224:225], v[224:225], v[196:197] op_sel:[0,1] op_sel_hi:[1,1]
v_cvt_pk_bf16_f32 v224, v224, v225
v_and_b32 v225, 0xffff0000, v224
v_lshlrev_b32 v224, 16, v224
v_lshlrev_b32 v242, 16, v189
v_and_b32 v243, 0xffff0000, v189
v_pk_add_f32 v[226:227], v[242:243], v[196:197] op_sel_hi:[1,0] neg_lo:[0,1] neg_hi:[0,1]
v_cvt_pk_bf16_f32 v226, v226, v227
v_and_b32 v227, 0xffff0000, v226
v_lshlrev_b32 v226, 16, v226
v_pk_mul_f32 v[226:227], v[226:227], v[196:197] op_sel:[0,1] op_sel_hi:[1,1]
v_cvt_pk_bf16_f32 v226, v226, v227
v_and_b32 v227, 0xffff0000, v226
v_lshlrev_b32 v226, 16, v226
v_lshlrev_b32 v244, 16, v190
v_and_b32 v245, 0xffff0000, v190
v_pk_add_f32 v[228:229], v[244:245], v[196:197] op_sel_hi:[1,0] neg_lo:[0,1] neg_hi:[0,1]
v_cvt_pk_bf16_f32 v228, v228, v229
v_and_b32 v229, 0xffff0000, v228
v_lshlrev_b32 v228, 16, v228
v_pk_mul_f32 v[228:229], v[228:229], v[196:197] op_sel:[0,1] op_sel_hi:[1,1]
v_cvt_pk_bf16_f32 v228, v228, v229
v_and_b32 v229, 0xffff0000, v228
v_lshlrev_b32 v228, 16, v228
v_lshlrev_b32 v246, 16, v191
v_and_b32 v247, 0xffff0000, v191
v_pk_add_f32 v[230:231], v[246:247], v[196:197] op_sel_hi:[1,0] neg_lo:[0,1] neg_hi:[0,1]
v_cvt_pk_bf16_f32 v230, v230, v231
v_and_b32 v231, 0xffff0000, v230
v_lshlrev_b32 v230, 16, v230
v_pk_mul_f32 v[230:231], v[230:231], v[196:197] op_sel:[0,1] op_sel_hi:[1,1]
v_cvt_pk_bf16_f32 v230, v230, v231
v_and_b32 v231, 0xffff0000, v230
v_lshlrev_b32 v230, 16, v230
s_mov_b32 s27, 0x20000

L_gt7:
v_cmp_eq_u32 vcc, s26, v162
v_cmp_eq_u32 s[56:57], s26, v166
s_sub_u32 s27, s27, 1
s_nop 3
s_and_b64 vcc, vcc, s[56:57]
s_cmp_eq_u64 vcc, -1
s_cbranch_scc1 L_gtd7
s_cmp_eq_u32 s27, 0
s_cbranch_scc1 L_gtd7
s_sleep 2
v_lshlrev_b32 v168, 5, v2
s_mov_b32 s55, 11796480
buffer_load_dwordx4 v[160:163], v168, s[20:23], s55 offen sc1
buffer_load_dwordx4 v[164:167], v168, s[20:23], s55 offen offset:16 sc1
s_waitcnt vmcnt(0)
s_branch L_gt7
L_gtd7:
v_max_u32 v169, v160, v164
s_nop 1
v_max_u32_dpp v169, v169, v169 row_shr:1 row_mask:0xf bank_mask:0xf bound_ctrl:0
s_nop 1
v_max_u32_dpp v169, v169, v169 row_shr:2 row_mask:0xf bank_mask:0xf bound_ctrl:0
s_nop 1
v_max_u32_dpp v169, v169, v169 row_shr:4 row_mask:0xf bank_mask:0xf bound_ctrl:0
s_nop 1
v_max_u32_dpp v169, v169, v169 row_shr:8 row_mask:0xf bank_mask:0xf bound_ctrl:0
s_nop 1
v_max_u32_dpp v169, v169, v169 row_bcast:15 row_mask:0xa bank_mask:0xf
s_nop 1
v_max_u32_dpp v169, v169, v169 row_bcast:31 row_mask:0xc bank_mask:0xf
s_nop 1
v_readlane_b32 s72, v169, 63
s_nop 3
v_cmp_ne_u32 vcc, s72, v160
v_cmp_ne_u32 s[56:57], s72, v164
s_nop 0
v_cndmask_b32 v160, v161, v160, vcc
v_cndmask_b32 v164, v165, v164, s[56:57]
v_max_u32 v169, v160, v164
s_nop 1
v_max_u32_dpp v169, v169, v169 row_shr:1 row_mask:0xf bank_mask:0xf bound_ctrl:0
s_nop 1
v_max_u32_dpp v169, v169, v169 row_shr:2 row_mask:0xf bank_mask:0xf bound_ctrl:0
s_nop 1
v_max_u32_dpp v169, v169, v169 row_shr:4 row_mask:0xf bank_mask:0xf bound_ctrl:0
s_nop 1
v_max_u32_dpp v169, v169, v169 row_shr:8 row_mask:0xf bank_mask:0xf bound_ctrl:0
s_nop 1
v_max_u32_dpp v169, v169, v169 row_bcast:15 row_mask:0xa bank_mask:0xf
s_nop 1
v_max_u32_dpp v169, v169, v169 row_bcast:31 row_mask:0xc bank_mask:0xf
s_nop 1
v_readlane_b32 s73, v169, 63
s_and_b32 s70, s72, 0x7ff
s_sub_u32 s70, 2047, s70
s_nop 2
s_and_b32 s71, s73, 0x7ff
s_sub_u32 s71, 2047, s71
L_att_hx:
s_mov_b32 s8, s68
s_mov_b32 s9, s69
s_mov_b32 s10, 819200
s_mov_b32 s11, 0x20000
s_mov_b32 s94, 429496730
v_add_u32 v206, 0, v2
v_mul_hi_u32 v207, v206, s94
v_mul_u32_u24 v208, 10, v207
v_sub_u32 v208, v206, v208
v_mul_u32_u24 v207, 1280, v207
v_lshlrev_b32 v208, 4, v208
v_add_u32 v210, v207, v208
v_add_u32 v206, 64, v2
v_mul_hi_u32 v207, v206, s94
v_mul_u32_u24 v208, 10, v207
v_sub_u32 v208, v206, v208
v_mul_u32_u24 v207, 1280, v207
v_lshlrev_b32 v208, 4, v208
v_add_u32 v211, v207, v208
v_add_u32 v206, 128, v2
v_mul_hi_u32 v207, v206, s94
v_mul_u32_u24 v208, 10, v207
v_sub_u32 v208, v206, v208
v_mul_u32_u24 v207, 1280, v207
v_lshlrev_b32 v208, 4, v208
v_add_u32 v212, v207, v208
v_add_u32 v206, 192, v2
v_mul_hi_u32 v207, v206, s94
v_mul_u32_u24 v208, 10, v207
v_sub_u32 v208, v206, v208
v_mul_u32_u24 v207, 1280, v207
v_lshlrev_b32 v208, 4, v208
v_add_u32 v213, v207, v208
v_add_u32 v206, 256, v2
v_mul_hi_u32 v207, v206, s94
v_mul_u32_u24 v208, 10, v207
v_sub_u32 v208, v206, v208
v_mul_u32_u24 v207, 1280, v207
v_lshlrev_b32 v208, 4, v208
v_add_u32 v214, v207, v208
s_lshr_b32 s88, s30, 1
s_mul_i32 s89, s88, 204800
s_mul_i32 s90, s99, 160
s_add_u32 s89, s89, s90
s_mul_i32 s90, s88, 25728
s_add_u32 s90, s90, 49152
s_and_b32 s88, s30, 1
s_mul_i32 s91, s88, 40960
s_add_u32 s89, s89, s91
s_mul_i32 s91, s88, 5120
s_add_u32 s90, s90, s91
s_lshl_b32 s44, s41, 8
v_add_u32 v8, s44, v14
v_add_u32 v9, s44, v15
v_mov_b32 v18, 43328
v_cndmask_b32 v9, v9, v18, s[62:63]
v_add_u32 v10, s44, v17
v_mov_b32 v18, 45696
v_cndmask_b32 v10, v10, v18, s[60:61]
s_waitcnt vmcnt(0) lgkmcnt(0)
s_barrier
s_mov_b32 s50, 0
ds_read_b64 v[40:41], v8 offset:2048
ds_read_b64 v[42:43], v8 offset:6176
ds_read_b64 v[44:45], v9 offset:2048
s_cmp_eq_u32 s31, 0
s_cbranch_scc0 L_att_pre_p
v_cndmask_b32_e64 v36, v36, 0, s[62:63]
v_cndmask_b32_e64 v37, v37, 0, s[62:63]
s_waitcnt lgkmcnt(0)
s_nop 0
v_mfma_f32_32x32x16_bf16 v[64:79], v[40:43], v[32:35], v[120:135]
v_mfma_f32_32x32x8_bf16 v[64:79], v[44:45], v[36:37], v[64:79]
v_mov_b32 v104, 0
v_mov_b32 v105, 0
v_mov_b32 v106, 0
v_mov_b32 v107, 0
v_mov_b32 v108, 0
v_mov_b32 v109, 0
v_mov_b32 v110, 0
v_mov_b32 v111, 0
v_mov_b32 v112, 0
v_mov_b32 v113, 0
v_mov_b32 v114, 0
v_mov_b32 v115, 0
v_mov_b32 v116, 0
v_mov_b32 v117, 0
v_mov_b32 v118, 0
v_mov_b32 v119, 0
v_max3_f32 v22, v64, v65, v66
v_max3_f32 v22, v22, v67, v68
v_max3_f32 v22, v22, v69, v70
v_max3_f32 v22, v22, v71, v72
v_max3_f32 v22, v22, v73, v74
v_max3_f32 v22, v22, v75, v76
v_max3_f32 v22, v22, v77, v78
v_max_f32 v22, v22, v79
v_mov_b32 v23, v22
s_nop 1
v_permlane32_swap_b32 v22, v23
s_nop 1
v_max_f32 v22, v22, v23
s_branch L_att_run
L_att_pre_p:
ds_read_b64 v[46:47], v8 offset:0
ds_read_b64 v[48:49], v8 offset:4128
ds_read_b64 v[50:51], v9 offset:0
v_cndmask_b32_e64 v36, v36, 0, s[62:63]
v_cndmask_b32_e64 v37, v37, 0, s[62:63]
v_cndmask_b32_e64 v156, v156, 0, s[62:63]
v_cndmask_b32_e64 v157, v157, 0, s[62:63]
v_mov_b32 v176, v32
v_mov_b32 v177, v33
v_mov_b32 v178, v34
v_mov_b32 v179, v35
v_mov_b32 v180, v36
v_mov_b32 v181, v37
s_waitcnt lgkmcnt(0)
v_mfma_f32_32x32x16_bf16 v[64:79], v[40:43], v[152:155], v[120:135]
v_mfma_f32_32x32x8_bf16 v[64:79], v[44:45], v[156:157], v[64:79]
v_mfma_f32_32x32x16_bf16 v[80:95], v[46:49], v[32:35], v[136:151]
v_mfma_f32_32x32x8_bf16 v[80:95], v[50:51], v[36:37], v[80:95]
v_mov_b32 v104, 0
v_mov_b32 v105, 0
v_mov_b32 v106, 0
v_mov_b32 v107, 0
v_mov_b32 v108, 0
v_mov_b32 v109, 0
v_mov_b32 v110, 0
v_mov_b32 v111, 0
v_mov_b32 v112, 0
v_mov_b32 v113, 0
v_mov_b32 v114, 0
v_mov_b32 v115, 0
v_mov_b32 v116, 0
v_mov_b32 v117, 0
v_mov_b32 v118, 0
v_mov_b32 v119, 0
v_max3_f32 v22, v64, v65, v66
v_max3_f32 v22, v22, v67, v68
v_max3_f32 v22, v22, v69, v70
v_max3_f32 v22, v22, v71, v72
v_max3_f32 v22, v22, v73, v74
v_max3_f32 v22, v22, v75, v76
v_max3_f32 v22, v22, v77, v78
v_max_f32 v22, v22, v79
v_max3_f32 v26, v80, v81, v82
v_max3_f32 v26, v26, v83, v84
v_max3_f32 v26, v26, v85, v86
v_max3_f32 v26, v26, v87, v88
v_max3_f32 v26, v26, v89, v90
v_max3_f32 v26, v26, v91, v92
v_max3_f32 v26, v26, v93, v94
v_max_f32 v26, v26, v95
v_mov_b32 v23, v22
s_nop 1
v_permlane32_swap_b32 v22, v23
s_nop 1
v_max_f32 v22, v22, v23
v_mov_b32 v23, v26
s_nop 1
v_permlane32_swap_b32 v26, v23
s_nop 1
v_max_f32 v26, v26, v23
L_att_run:
ds_read_b64 v[40:41], v8 offset:0
ds_read_b64 v[42:43], v8 offset:4128
ds_read_b64 v[44:45], v9 offset:0
ds_read_b64 v[46:47], v8 offset:256
ds_read_b64 v[48:49], v8 offset:4384
ds_read_b64 v[50:51], v9 offset:256
s_cmp_eq_u32 s31, 0
s_cbranch_scc0 L_att_ex_p
v_xor_b32 v18, 0x80000000, v22
v_and_b32 v19, 0xffff0000, v18
v_sub_f32 v20, v18, v19
v_and_b32 v21, 0xffff0000, v20
v_sub_f32 v20, v20, v21
s_mov_b32 s47, 0x07060302
v_perm_b32 v19, v21, v19, s47
v_lshrrev_b32 v20, 16, v20
v_cndmask_b32 v36, v36, v19, s[62:63]
v_cndmask_b32 v37, v37, v20, s[62:63]
s_branch L_att_ex_d
L_att_ex_p:
v_xor_b32 v18, 0x80000000, v22
v_and_b32 v19, 0xffff0000, v18
v_sub_f32 v20, v18, v19
v_and_b32 v21, 0xffff0000, v20
v_sub_f32 v20, v20, v21
s_mov_b32 s47, 0x07060302
v_perm_b32 v19, v21, v19, s47
v_lshrrev_b32 v20, 16, v20
v_cndmask_b32 v156, v156, v19, s[62:63]
v_cndmask_b32 v157, v157, v20, s[62:63]
v_xor_b32 v18, 0x80000000, v26
v_and_b32 v19, 0xffff0000, v18
v_sub_f32 v20, v18, v19
v_and_b32 v21, 0xffff0000, v20
v_sub_f32 v20, v20, v21
s_mov_b32 s47, 0x07060302
v_perm_b32 v19, v21, v19, s47
v_lshrrev_b32 v20, 16, v20
v_cndmask_b32 v36, v36, v19, s[62:63]
v_cndmask_b32 v37, v37, v20, s[62:63]
L_att_ex_d:
s_waitcnt lgkmcnt(3)
s_nop 0
v_mfma_f32_32x32x16_bf16 v[64:79], v[40:43], v[32:35], v[136:151]
v_mfma_f32_32x32x8_bf16 v[64:79], v[44:45], v[36:37], v[64:79]
s_nop 7
L_att_stage0:
ds_read_b64_tr_b16 v[52:53], v10 offset:0
ds_read_b64_tr_b16 v[54:55], v10 offset:32
ds_read_b64_tr_b16 v[56:57], v10 offset:128
ds_read_b64_tr_b16 v[58:59], v10 offset:160
s_add_u32 m0, s90, 0
s_add_u32 s91, s89, 0
buffer_load_dwordx4 v210, s[8:11], s91 offen lds
s_add_u32 m0, s90, 1024
s_add_u32 s91, s89, 0
buffer_load_dwordx4 v211, s[8:11], s91 offen lds
s_cmp_eq_u32 s49, 1
s_cbranch_scc0 L_att_qs0
v_mov_b32 v32, v152
v_mov_b32 v33, v153
v_mov_b32 v34, v154
v_mov_b32 v35, v155
v_mov_b32 v36, v156
v_mov_b32 v37, v157
L_att_qs0:
ds_read_b64 v[40:41], v8 offset:512
ds_read_b64 v[42:43], v8 offset:4640
ds_read_b64 v[44:45], v9 offset:512
s_waitcnt lgkmcnt(7)
v_mfma_f32_32x32x16_bf16 v[80:95], v[46:49], v[32:35], 0
v_exp_f32 v64, v64
v_exp_f32 v65, v65
v_exp_f32 v66, v66
v_exp_f32 v67, v67
v_mfma_f32_32x32x8_bf16 v[80:95], v[50:51], v[36:37], v[80:95]
v_exp_f32 v68, v68
v_exp_f32 v69, v69
v_exp_f32 v70, v70
v_exp_f32 v71, v71
v_cvt_pk_bf16_f32 v96, v64, v65
v_cvt_pk_bf16_f32 v97, v66, v67
v_exp_f32 v72, v72
v_cvt_pk_bf16_f32 v98, v68, v69
v_cvt_pk_bf16_f32 v99, v70, v71
v_exp_f32 v73, v73
s_waitcnt lgkmcnt(3)
v_exp_f32 v74, v74
v_mfma_f32_32x32x16_bf16 v[104:119], v[52:55], v[96:99], v[104:119]
v_exp_f32 v75, v75
v_exp_f32 v76, v76
v_exp_f32 v77, v77
v_exp_f32 v78, v78
v_exp_f32 v79, v79
v_cvt_pk_bf16_f32 v100, v72, v73
v_cvt_pk_bf16_f32 v101, v74, v75
v_cvt_pk_bf16_f32 v102, v76, v77
s_nop 0
v_cvt_pk_bf16_f32 v103, v78, v79
s_nop 1
v_mfma_f32_32x32x16_bf16 v[104:119], v[56:59], v[100:103], v[104:119]
L_att_stage1:
s_cmp_eq_u32 s49, 1
s_cbranch_scc0 L_att_os1
s_nop 13
v_mov_b32 v160, v104
v_mov_b32 v161, v105
v_mov_b32 v162, v106
v_mov_b32 v163, v107
v_mov_b32 v164, v108
v_mov_b32 v165, v109
v_mov_b32 v166, v110
v_mov_b32 v167, v111
v_mov_b32 v168, v112
v_mov_b32 v169, v113
v_mov_b32 v170, v114
v_mov_b32 v171, v115
v_mov_b32 v172, v116
v_mov_b32 v173, v117
v_mov_b32 v174, v118
v_mov_b32 v175, v119
v_mov_b32 v104, 0
v_mov_b32 v105, 0
v_mov_b32 v106, 0
v_mov_b32 v107, 0
v_mov_b32 v108, 0
v_mov_b32 v109, 0
v_mov_b32 v110, 0
v_mov_b32 v111, 0
v_mov_b32 v112, 0
v_mov_b32 v113, 0
v_mov_b32 v114, 0
v_mov_b32 v115, 0
v_mov_b32 v116, 0
v_mov_b32 v117, 0
v_mov_b32 v118, 0
v_mov_b32 v119, 0
L_att_os1:
ds_read_b64_tr_b16 v[52:53], v10 offset:256
ds_read_b64_tr_b16 v[54:55], v10 offset:288
ds_read_b64_tr_b16 v[56:57], v10 offset:384
ds_read_b64_tr_b16 v[58:59], v10 offset:416
s_add_u32 m0, s90, 2048
s_add_u32 s91, s89, 0
buffer_load_dwordx4 v212, s[8:11], s91 offen lds
s_add_u32 m0, s90, 3072
s_add_u32 s91, s89, 0
buffer_load_dwordx4 v213, s[8:11], s91 offen lds
s_cmp_eq_u32 s49, 2
s_cbranch_scc0 L_att_qs1
v_mov_b32 v32, v152
v_mov_b32 v33, v153
v_mov_b32 v34, v154
v_mov_b32 v35, v155
v_mov_b32 v36, v156
v_mov_b32 v37, v157
L_att_qs1:
ds_read_b64 v[46:47], v8 offset:768
ds_read_b64 v[48:49], v8 offset:4896
ds_read_b64 v[50:51], v9 offset:768
s_waitcnt lgkmcnt(7)
v_mfma_f32_32x32x16_bf16 v[64:79], v[40:43], v[32:35], 0
v_exp_f32 v80, v80
v_exp_f32 v81, v81
v_exp_f32 v82, v82
v_exp_f32 v83, v83
v_mfma_f32_32x32x8_bf16 v[64:79], v[44:45], v[36:37], v[64:79]
v_exp_f32 v84, v84
v_exp_f32 v85, v85
v_exp_f32 v86, v86
v_exp_f32 v87, v87
v_cvt_pk_bf16_f32 v96, v80, v81
v_cvt_pk_bf16_f32 v97, v82, v83
v_exp_f32 v88, v88
v_cvt_pk_bf16_f32 v98, v84, v85
v_cvt_pk_bf16_f32 v99, v86, v87
v_exp_f32 v89, v89
s_waitcnt lgkmcnt(3)
v_exp_f32 v90, v90
v_mfma_f32_32x32x16_bf16 v[104:119], v[52:55], v[96:99], v[104:119]
v_exp_f32 v91, v91
v_exp_f32 v92, v92
v_exp_f32 v93, v93
v_exp_f32 v94, v94
v_exp_f32 v95, v95
v_cvt_pk_bf16_f32 v100, v88, v89
v_cvt_pk_bf16_f32 v101, v90, v91
v_cvt_pk_bf16_f32 v102, v92, v93
s_nop 0
v_cvt_pk_bf16_f32 v103, v94, v95
s_nop 1
v_mfma_f32_32x32x16_bf16 v[104:119], v[56:59], v[100:103], v[104:119]
L_att_stage2:
s_cmp_eq_u32 s49, 2
s_cbranch_scc0 L_att_os2
s_nop 13
v_mov_b32 v160, v104
v_mov_b32 v161, v105
v_mov_b32 v162, v106
v_mov_b32 v163, v107
v_mov_b32 v164, v108
v_mov_b32 v165, v109
v_mov_b32 v166, v110
v_mov_b32 v167, v111
v_mov_b32 v168, v112
v_mov_b32 v169, v113
v_mov_b32 v170, v114
v_mov_b32 v171, v115
v_mov_b32 v172, v116
v_mov_b32 v173, v117
v_mov_b32 v174, v118
v_mov_b32 v175, v119
v_mov_b32 v104, 0
v_mov_b32 v105, 0
v_mov_b32 v106, 0
v_mov_b32 v107, 0
v_mov_b32 v108, 0
v_mov_b32 v109, 0
v_mov_b32 v110, 0
v_mov_b32 v111, 0
v_mov_b32 v112, 0
v_mov_b32 v113, 0
v_mov_b32 v114, 0
v_mov_b32 v115, 0
v_mov_b32 v116, 0
v_mov_b32 v117, 0
v_mov_b32 v118, 0
v_mov_b32 v119, 0
L_att_os2:
ds_read_b64_tr_b16 v[52:53], v10 offset:512
ds_read_b64_tr_b16 v[54:55], v10 offset:544
ds_read_b64_tr_b16 v[56:57], v10 offset:640
ds_read_b64_tr_b16 v[58:59], v10 offset:672
s_add_u32 m0, s90, 4096
s_add_u32 s91, s89, 0
buffer_load_dwordx4 v214, s[8:11], s91 offen lds
s_add_u32 m0, s90, 10240
s_add_u32 s91, s89, 81920
buffer_load_dwordx4 v210, s[8:11], s91 offen lds
s_cmp_eq_u32 s49, 3
s_cbranch_scc0 L_att_qs2
v_mov_b32 v32, v152
v_mov_b32 v33, v153
v_mov_b32 v34, v154
v_mov_b32 v35, v155
v_mov_b32 v36, v156
v_mov_b32 v37, v157
L_att_qs2:
ds_read_b64 v[40:41], v8 offset:1024
ds_read_b64 v[42:43], v8 offset:5152
ds_read_b64 v[44:45], v9 offset:1024
s_waitcnt lgkmcnt(7)
v_mfma_f32_32x32x16_bf16 v[80:95], v[46:49], v[32:35], 0
v_exp_f32 v64, v64
v_exp_f32 v65, v65
v_exp_f32 v66, v66
v_exp_f32 v67, v67
v_mfma_f32_32x32x8_bf16 v[80:95], v[50:51], v[36:37], v[80:95]
v_exp_f32 v68, v68
v_exp_f32 v69, v69
v_exp_f32 v70, v70
v_exp_f32 v71, v71
v_cvt_pk_bf16_f32 v96, v64, v65
v_cvt_pk_bf16_f32 v97, v66, v67
v_exp_f32 v72, v72
v_cvt_pk_bf16_f32 v98, v68, v69
v_cvt_pk_bf16_f32 v99, v70, v71
v_exp_f32 v73, v73
s_waitcnt lgkmcnt(3)
v_exp_f32 v74, v74
v_mfma_f32_32x32x16_bf16 v[104:119], v[52:55], v[96:99], v[104:119]
v_exp_f32 v75, v75
v_exp_f32 v76, v76
v_exp_f32 v77, v77
v_exp_f32 v78, v78
v_exp_f32 v79, v79
v_cvt_pk_bf16_f32 v100, v72, v73
v_cvt_pk_bf16_f32 v101, v74, v75
v_cvt_pk_bf16_f32 v102, v76, v77
s_nop 0
v_cvt_pk_bf16_f32 v103, v78, v79
s_nop 1
v_mfma_f32_32x32x16_bf16 v[104:119], v[56:59], v[100:103], v[104:119]
L_att_stage3:
s_cmp_eq_u32 s49, 3
s_cbranch_scc0 L_att_os3
s_nop 13
v_mov_b32 v160, v104
v_mov_b32 v161, v105
v_mov_b32 v162, v106
v_mov_b32 v163, v107
v_mov_b32 v164, v108
v_mov_b32 v165, v109
v_mov_b32 v166, v110
v_mov_b32 v167, v111
v_mov_b32 v168, v112
v_mov_b32 v169, v113
v_mov_b32 v170, v114
v_mov_b32 v171, v115
v_mov_b32 v172, v116
v_mov_b32 v173, v117
v_mov_b32 v174, v118
v_mov_b32 v175, v119
v_mov_b32 v104, 0
v_mov_b32 v105, 0
v_mov_b32 v106, 0
v_mov_b32 v107, 0
v_mov_b32 v108, 0
v_mov_b32 v109, 0
v_mov_b32 v110, 0
v_mov_b32 v111, 0
v_mov_b32 v112, 0
v_mov_b32 v113, 0
v_mov_b32 v114, 0
v_mov_b32 v115, 0
v_mov_b32 v116, 0
v_mov_b32 v117, 0
v_mov_b32 v118, 0
v_mov_b32 v119, 0
L_att_os3:
ds_read_b64_tr_b16 v[52:53], v10 offset:768
ds_read_b64_tr_b16 v[54:55], v10 offset:800
ds_read_b64_tr_b16 v[56:57], v10 offset:896
ds_read_b64_tr_b16 v[58:59], v10 offset:928
s_add_u32 m0, s90, 11264
s_add_u32 s91, s89, 81920
buffer_load_dwordx4 v211, s[8:11], s91 offen lds
s_add_u32 m0, s90, 12288
s_add_u32 s91, s89, 81920
buffer_load_dwordx4 v212, s[8:11], s91 offen lds
s_cmp_eq_u32 s49, 4
s_cbranch_scc0 L_att_qs3
v_mov_b32 v32, v152
v_mov_b32 v33, v153
v_mov_b32 v34, v154
v_mov_b32 v35, v155
v_mov_b32 v36, v156
v_mov_b32 v37, v157
L_att_qs3:
ds_read_b64 v[46:47], v8 offset:1280
ds_read_b64 v[48:49], v8 offset:5408
ds_read_b64 v[50:51], v9 offset:1280
s_waitcnt lgkmcnt(7)
v_mfma_f32_32x32x16_bf16 v[64:79], v[40:43], v[32:35], 0
v_exp_f32 v80, v80
v_exp_f32 v81, v81
v_exp_f32 v82, v82
v_exp_f32 v83, v83
v_mfma_f32_32x32x8_bf16 v[64:79], v[44:45], v[36:37], v[64:79]
v_exp_f32 v84, v84
v_exp_f32 v85, v85
v_exp_f32 v86, v86
v_exp_f32 v87, v87
v_cvt_pk_bf16_f32 v96, v80, v81
v_cvt_pk_bf16_f32 v97, v82, v83
v_exp_f32 v88, v88
v_cvt_pk_bf16_f32 v98, v84, v85
v_cvt_pk_bf16_f32 v99, v86, v87
v_exp_f32 v89, v89
s_waitcnt lgkmcnt(3)
v_exp_f32 v90, v90
v_mfma_f32_32x32x16_bf16 v[104:119], v[52:55], v[96:99], v[104:119]
v_exp_f32 v91, v91
v_exp_f32 v92, v92
v_exp_f32 v93, v93
v_exp_f32 v94, v94
v_exp_f32 v95, v95
v_cvt_pk_bf16_f32 v100, v88, v89
v_cvt_pk_bf16_f32 v101, v90, v91
v_cvt_pk_bf16_f32 v102, v92, v93
s_nop 0
v_cvt_pk_bf16_f32 v103, v94, v95
s_nop 1
v_mfma_f32_32x32x16_bf16 v[104:119], v[56:59], v[100:103], v[104:119]
L_att_stage4:
s_cmp_eq_u32 s49, 4
s_cbranch_scc0 L_att_os4
s_nop 13
v_mov_b32 v160, v104
v_mov_b32 v161, v105
v_mov_b32 v162, v106
v_mov_b32 v163, v107
v_mov_b32 v164, v108
v_mov_b32 v165, v109
v_mov_b32 v166, v110
v_mov_b32 v167, v111
v_mov_b32 v168, v112
v_mov_b32 v169, v113
v_mov_b32 v170, v114
v_mov_b32 v171, v115
v_mov_b32 v172, v116
v_mov_b32 v173, v117
v_mov_b32 v174, v118
v_mov_b32 v175, v119
v_mov_b32 v104, 0
v_mov_b32 v105, 0
v_mov_b32 v106, 0
v_mov_b32 v107, 0
v_mov_b32 v108, 0
v_mov_b32 v109, 0
v_mov_b32 v110, 0
v_mov_b32 v111, 0
v_mov_b32 v112, 0
v_mov_b32 v113, 0
v_mov_b32 v114, 0
v_mov_b32 v115, 0
v_mov_b32 v116, 0
v_mov_b32 v117, 0
v_mov_b32 v118, 0
v_mov_b32 v119, 0
L_att_os4:
ds_read_b64_tr_b16 v[52:53], v10 offset:1024
ds_read_b64_tr_b16 v[54:55], v10 offset:1056
ds_read_b64_tr_b16 v[56:57], v10 offset:1152
ds_read_b64_tr_b16 v[58:59], v10 offset:1184
s_add_u32 m0, s90, 13312
s_add_u32 s91, s89, 81920
buffer_load_dwordx4 v213, s[8:11], s91 offen lds
s_add_u32 m0, s90, 14336
s_add_u32 s91, s89, 81920
buffer_load_dwordx4 v214, s[8:11], s91 offen lds
s_cmp_eq_u32 s49, 5
s_cbranch_scc0 L_att_qs4
v_mov_b32 v32, v152
v_mov_b32 v33, v153
v_mov_b32 v34, v154
v_mov_b32 v35, v155
v_mov_b32 v36, v156
v_mov_b32 v37, v157
L_att_qs4:
ds_read_b64 v[40:41], v8 offset:1536
ds_read_b64 v[42:43], v8 offset:5664
ds_read_b64 v[44:45], v9 offset:1536
s_waitcnt lgkmcnt(7)
v_mfma_f32_32x32x16_bf16 v[80:95], v[46:49], v[32:35], 0
v_exp_f32 v64, v64
v_exp_f32 v65, v65
v_exp_f32 v66, v66
v_exp_f32 v67, v67
v_mfma_f32_32x32x8_bf16 v[80:95], v[50:51], v[36:37], v[80:95]
v_exp_f32 v68, v68
v_exp_f32 v69, v69
v_exp_f32 v70, v70
v_exp_f32 v71, v71
v_cvt_pk_bf16_f32 v96, v64, v65
v_cvt_pk_bf16_f32 v97, v66, v67
v_exp_f32 v72, v72
v_cvt_pk_bf16_f32 v98, v68, v69
v_cvt_pk_bf16_f32 v99, v70, v71
v_exp_f32 v73, v73
s_waitcnt lgkmcnt(3)
v_exp_f32 v74, v74
v_mfma_f32_32x32x16_bf16 v[104:119], v[52:55], v[96:99], v[104:119]
v_exp_f32 v75, v75
v_exp_f32 v76, v76
v_exp_f32 v77, v77
v_exp_f32 v78, v78
v_exp_f32 v79, v79
v_cvt_pk_bf16_f32 v100, v72, v73
v_cvt_pk_bf16_f32 v101, v74, v75
v_cvt_pk_bf16_f32 v102, v76, v77
s_nop 0
v_cvt_pk_bf16_f32 v103, v78, v79
s_nop 1
v_mfma_f32_32x32x16_bf16 v[104:119], v[56:59], v[100:103], v[104:119]
L_att_stage5:
s_setprio 0
s_cmp_eq_u32 s49, 5
s_cbranch_scc0 L_att_os5
s_nop 13
v_mov_b32 v160, v104
v_mov_b32 v161, v105
v_mov_b32 v162, v106
v_mov_b32 v163, v107
v_mov_b32 v164, v108
v_mov_b32 v165, v109
v_mov_b32 v166, v110
v_mov_b32 v167, v111
v_mov_b32 v168, v112
v_mov_b32 v169, v113
v_mov_b32 v170, v114
v_mov_b32 v171, v115
v_mov_b32 v172, v116
v_mov_b32 v173, v117
v_mov_b32 v174, v118
v_mov_b32 v175, v119
v_mov_b32 v104, 0
v_mov_b32 v105, 0
v_mov_b32 v106, 0
v_mov_b32 v107, 0
v_mov_b32 v108, 0
v_mov_b32 v109, 0
v_mov_b32 v110, 0
v_mov_b32 v111, 0
v_mov_b32 v112, 0
v_mov_b32 v113, 0
v_mov_b32 v114, 0
v_mov_b32 v115, 0
v_mov_b32 v116, 0
v_mov_b32 v117, 0
v_mov_b32 v118, 0
v_mov_b32 v119, 0
L_att_os5:
ds_read_b64_tr_b16 v[52:53], v10 offset:1280
ds_read_b64_tr_b16 v[54:55], v10 offset:1312
ds_read_b64_tr_b16 v[56:57], v10 offset:1408
ds_read_b64_tr_b16 v[58:59], v10 offset:1440
s_bitcmp1_b32 s30, 0
s_cbranch_scc1 L_wo_sk13
s_add_u32 m0, s90, 20480
s_add_u32 s91, s89, 163840
buffer_load_dwordx4 v210, s[8:11], s91 offen lds
s_add_u32 m0, s90, 21504
s_add_u32 s91, s89, 163840
buffer_load_dwordx4 v211, s[8:11], s91 offen lds
L_wo_sk13:
s_cmp_eq_u32 s49, 6
s_cbranch_scc0 L_att_qs5
v_mov_b32 v32, v152
v_mov_b32 v33, v153
v_mov_b32 v34, v154
v_mov_b32 v35, v155
v_mov_b32 v36, v156
v_mov_b32 v37, v157
L_att_qs5:
ds_read_b64 v[46:47], v8 offset:1792
ds_read_b64 v[48:49], v8 offset:5920
ds_read_b64 v[50:51], v9 offset:1792
s_waitcnt lgkmcnt(7)
v_mfma_f32_32x32x16_bf16 v[64:79], v[40:43], v[32:35], 0
v_exp_f32 v80, v80
v_exp_f32 v81, v81
v_exp_f32 v82, v82
v_exp_f32 v83, v83
v_mfma_f32_32x32x8_bf16 v[64:79], v[44:45], v[36:37], v[64:79]
v_exp_f32 v84, v84
v_exp_f32 v85, v85
v_exp_f32 v86, v86
v_exp_f32 v87, v87
v_cvt_pk_bf16_f32 v96, v80, v81
v_cvt_pk_bf16_f32 v97, v82, v83
v_exp_f32 v88, v88
v_cvt_pk_bf16_f32 v98, v84, v85
v_cvt_pk_bf16_f32 v99, v86, v87
v_exp_f32 v89, v89
s_waitcnt lgkmcnt(3)
v_exp_f32 v90, v90
v_mfma_f32_32x32x16_bf16 v[104:119], v[52:55], v[96:99], v[104:119]
v_exp_f32 v91, v91
v_exp_f32 v92, v92
v_exp_f32 v93, v93
v_exp_f32 v94, v94
v_exp_f32 v95, v95
v_cvt_pk_bf16_f32 v100, v88, v89
v_cvt_pk_bf16_f32 v101, v90, v91
v_cvt_pk_bf16_f32 v102, v92, v93
s_nop 0
v_cvt_pk_bf16_f32 v103, v94, v95
s_nop 1
v_mfma_f32_32x32x16_bf16 v[104:119], v[56:59], v[100:103], v[104:119]
L_att_stage6:
s_cmp_eq_u32 s49, 6
s_cbranch_scc0 L_att_os6
s_nop 13
v_mov_b32 v160, v104
v_mov_b32 v161, v105
v_mov_b32 v162, v106
v_mov_b32 v163, v107
v_mov_b32 v164, v108
v_mov_b32 v165, v109
v_mov_b32 v166, v110
v_mov_b32 v167, v111
v_mov_b32 v168, v112
v_mov_b32 v169, v113
v_mov_b32 v170, v114
v_mov_b32 v171, v115
v_mov_b32 v172, v116
v_mov_b32 v173, v117
v_mov_b32 v174, v118
v_mov_b32 v175, v119
v_mov_b32 v104, 0
v_mov_b32 v105, 0
v_mov_b32 v106, 0
v_mov_b32 v107, 0
v_mov_b32 v108, 0
v_mov_b32 v109, 0
v_mov_b32 v110, 0
v_mov_b32 v111, 0
v_mov_b32 v112, 0
v_mov_b32 v113, 0
v_mov_b32 v114, 0
v_mov_b32 v115, 0
v_mov_b32 v116, 0
v_mov_b32 v117, 0
v_mov_b32 v118, 0
v_mov_b32 v119, 0
L_att_os6:
ds_read_b64_tr_b16 v[52:53], v10 offset:1536
ds_read_b64_tr_b16 v[54:55], v10 offset:1568
ds_read_b64_tr_b16 v[56:57], v10 offset:1664
ds_read_b64_tr_b16 v[58:59], v10 offset:1696
s_bitcmp1_b32 s30, 0
s_cbranch_scc1 L_wo_sk14
s_add_u32 m0, s90, 22528
s_add_u32 s91, s89, 163840
buffer_load_dwordx4 v212, s[8:11], s91 offen lds
s_add_u32 m0, s90, 23552
s_add_u32 s91, s89, 163840
buffer_load_dwordx4 v213, s[8:11], s91 offen lds
L_wo_sk14:
s_cmp_eq_u32 s49, 7
s_cbranch_scc0 L_att_qs6
v_mov_b32 v32, v152
v_mov_b32 v33, v153
v_mov_b32 v34, v154
v_mov_b32 v35, v155
v_mov_b32 v36, v156
v_mov_b32 v37, v157
L_att_qs6:
ds_read_b64 v[40:41], v8 offset:2048
ds_read_b64 v[42:43], v8 offset:6176
ds_read_b64 v[44:45], v9 offset:2048
s_waitcnt lgkmcnt(7)
v_mfma_f32_32x32x16_bf16 v[80:95], v[46:49], v[32:35], 0
v_exp_f32 v64, v64
v_exp_f32 v65, v65
v_exp_f32 v66, v66
v_exp_f32 v67, v67
v_mfma_f32_32x32x8_bf16 v[80:95], v[50:51], v[36:37], v[80:95]
v_exp_f32 v68, v68
v_exp_f32 v69, v69
v_exp_f32 v70, v70
v_exp_f32 v71, v71
v_cvt_pk_bf16_f32 v96, v64, v65
v_cvt_pk_bf16_f32 v97, v66, v67
v_exp_f32 v72, v72
v_cvt_pk_bf16_f32 v98, v68, v69
v_cvt_pk_bf16_f32 v99, v70, v71
v_exp_f32 v73, v73
s_waitcnt lgkmcnt(3)
v_exp_f32 v74, v74
v_mfma_f32_32x32x16_bf16 v[104:119], v[52:55], v[96:99], v[104:119]
v_exp_f32 v75, v75
v_exp_f32 v76, v76
v_exp_f32 v77, v77
v_exp_f32 v78, v78
v_exp_f32 v79, v79
v_cvt_pk_bf16_f32 v100, v72, v73
v_cvt_pk_bf16_f32 v101, v74, v75
v_cvt_pk_bf16_f32 v102, v76, v77
s_nop 0
v_cvt_pk_bf16_f32 v103, v78, v79
s_nop 1
v_mfma_f32_32x32x16_bf16 v[104:119], v[56:59], v[100:103], v[104:119]
L_att_stage7:
s_cmp_eq_u32 s49, 7
s_cbranch_scc0 L_att_os7
s_nop 13
v_mov_b32 v160, v104
v_mov_b32 v161, v105
v_mov_b32 v162, v106
v_mov_b32 v163, v107
v_mov_b32 v164, v108
v_mov_b32 v165, v109
v_mov_b32 v166, v110
v_mov_b32 v167, v111
v_mov_b32 v168, v112
v_mov_b32 v169, v113
v_mov_b32 v170, v114
v_mov_b32 v171, v115
v_mov_b32 v172, v116
v_mov_b32 v173, v117
v_mov_b32 v174, v118
v_mov_b32 v175, v119
v_mov_b32 v104, 0
v_mov_b32 v105, 0
v_mov_b32 v106, 0
v_mov_b32 v107, 0
v_mov_b32 v108, 0
v_mov_b32 v109, 0
v_mov_b32 v110, 0
v_mov_b32 v111, 0
v_mov_b32 v112, 0
v_mov_b32 v113, 0
v_mov_b32 v114, 0
v_mov_b32 v115, 0
v_mov_b32 v116, 0
v_mov_b32 v117, 0
v_mov_b32 v118, 0
v_mov_b32 v119, 0
L_att_os7:
ds_read_b64_tr_b16 v[52:53], v10 offset:1792
ds_read_b64_tr_b16 v[54:55], v10 offset:1824
ds_read_b64_tr_b16 v[56:57], v10 offset:1920
ds_read_b64_tr_b16 v[58:59], v10 offset:1952
s_bitcmp1_b32 s30, 0
s_cbranch_scc1 L_wo_sk15
s_add_u32 m0, s90, 24576
s_add_u32 s91, s89, 163840
buffer_load_dwordx4 v214, s[8:11], s91 offen lds
L_wo_sk15:
s_cmp_eq_u32 s49, 8
s_cbranch_scc0 L_att_qs7
v_mov_b32 v32, v152
v_mov_b32 v33, v153
v_mov_b32 v34, v154
v_mov_b32 v35, v155
v_mov_b32 v36, v156
v_mov_b32 v37, v157
L_att_qs7:
s_waitcnt lgkmcnt(4)
s_nop 0
v_mfma_f32_32x32x16_bf16 v[64:79], v[40:43], v[32:35], v[120:135]
v_exp_f32 v80, v80
v_exp_f32 v81, v81
v_exp_f32 v82, v82
v_exp_f32 v83, v83
v_mfma_f32_32x32x8_bf16 v[64:79], v[44:45], v[36:37], v[64:79]
v_exp_f32 v84, v84
v_exp_f32 v85, v85
v_exp_f32 v86, v86
v_exp_f32 v87, v87
v_cvt_pk_bf16_f32 v96, v80, v81
v_cvt_pk_bf16_f32 v97, v82, v83
v_exp_f32 v88, v88
v_cvt_pk_bf16_f32 v98, v84, v85
v_cvt_pk_bf16_f32 v99, v86, v87
v_exp_f32 v89, v89
s_waitcnt lgkmcnt(0)
v_exp_f32 v90, v90
v_mfma_f32_32x32x16_bf16 v[104:119], v[52:55], v[96:99], v[104:119]
v_exp_f32 v91, v91
v_exp_f32 v92, v92
v_exp_f32 v93, v93
v_exp_f32 v94, v94
v_exp_f32 v95, v95
v_cvt_pk_bf16_f32 v100, v88, v89
v_cvt_pk_bf16_f32 v101, v90, v91
v_cvt_pk_bf16_f32 v102, v92, v93
s_nop 0
v_cvt_pk_bf16_f32 v103, v94, v95
s_nop 1
v_mfma_f32_32x32x16_bf16 v[104:119], v[56:59], v[100:103], v[104:119]
L_att_stage8:
s_cmp_eq_u32 s49, 8
s_cbranch_scc0 L_att_os8
s_nop 13
v_mov_b32 v160, v104
v_mov_b32 v161, v105
v_mov_b32 v162, v106
v_mov_b32 v163, v107
v_mov_b32 v164, v108
v_mov_b32 v165, v109
v_mov_b32 v166, v110
v_mov_b32 v167, v111
v_mov_b32 v168, v112
v_mov_b32 v169, v113
v_mov_b32 v170, v114
v_mov_b32 v171, v115
v_mov_b32 v172, v116
v_mov_b32 v173, v117
v_mov_b32 v174, v118
v_mov_b32 v175, v119
v_mov_b32 v104, 0
v_mov_b32 v105, 0
v_mov_b32 v106, 0
v_mov_b32 v107, 0
v_mov_b32 v108, 0
v_mov_b32 v109, 0
v_mov_b32 v110, 0
v_mov_b32 v111, 0
v_mov_b32 v112, 0
v_mov_b32 v113, 0
v_mov_b32 v114, 0
v_mov_b32 v115, 0
v_mov_b32 v116, 0
v_mov_b32 v117, 0
v_mov_b32 v118, 0
v_mov_b32 v119, 0
L_att_os8:
ds_read_b64_tr_b16 v[52:53], v10 offset:2048
ds_read_b64_tr_b16 v[54:55], v10 offset:2080
ds_read_b64_tr_b16 v[56:57], v10 offset:2176
ds_read_b64_tr_b16 v[58:59], v10 offset:2208
s_nop 4
v_exp_f32 v64, v64
v_exp_f32 v65, v65
v_exp_f32 v66, v66
v_exp_f32 v67, v67
v_exp_f32 v68, v68
v_exp_f32 v69, v69
v_exp_f32 v70, v70
v_exp_f32 v71, v71
v_cvt_pk_bf16_f32 v96, v64, v65
v_cvt_pk_bf16_f32 v97, v66, v67
v_exp_f32 v72, v72
v_cvt_pk_bf16_f32 v98, v68, v69
v_cvt_pk_bf16_f32 v99, v70, v71
v_exp_f32 v73, v73
s_waitcnt lgkmcnt(0)
v_exp_f32 v74, v74
v_mfma_f32_32x32x16_bf16 v[104:119], v[52:55], v[96:99], v[104:119]
v_exp_f32 v75, v75
v_exp_f32 v76, v76
v_exp_f32 v77, v77
v_exp_f32 v78, v78
v_exp_f32 v79, v79
v_cvt_pk_bf16_f32 v100, v72, v73
v_cvt_pk_bf16_f32 v101, v74, v75
v_cvt_pk_bf16_f32 v102, v76, v77
s_nop 0
v_cvt_pk_bf16_f32 v103, v78, v79
s_nop 1
v_mfma_f32_32x32x16_bf16 v[104:119], v[56:59], v[100:103], v[104:119]

s_nop 13
v_mov_b32 v18, 0x53800000
v_cmp_nlt_f32 vcc, v116, v18
v_cmp_nlt_f32 s[56:57], v172, v18
s_cmp_lg_u32 s50, 0
s_cbranch_scc1 L_att_fin
s_cmp_eq_u32 s31, 0
s_cselect_b64 s[56:57], 0, s[56:57]
s_or_b64 vcc, vcc, s[56:57]
s_cmp_eq_u64 vcc, 0
s_cbranch_scc1 L_att_fin
s_mov_b32 s50, 1
s_cmp_eq_u32 s31, 0
s_cbranch_scc1 L_att_sl0
v_mov_b32 v32, v176
v_mov_b32 v33, v177
v_mov_b32 v34, v178
v_mov_b32 v35, v179
v_mov_b32 v36, v180
v_mov_b32 v37, v181
v_cndmask_b32_e64 v156, v156, 0, s[62:63]
v_cndmask_b32_e64 v157, v157, 0, s[62:63]
L_att_sl0:
v_cndmask_b32_e64 v36, v36, 0, s[62:63]
v_cndmask_b32_e64 v37, v37, 0, s[62:63]
v_mov_b32 v22, 0xf149f2ca
s_mov_b32 s51, 0
v_mov_b32 v24, v8
v_mov_b32 v25, v9
L_att_slow:
s_cmp_eq_u32 s51, s49
s_cbranch_scc0 L_att_sl1
v_mov_b32 v26, v22
v_mov_b32 v22, 0xf149f2ca
v_mov_b32 v32, v152
v_mov_b32 v33, v153
v_mov_b32 v34, v154
v_mov_b32 v35, v155
v_mov_b32 v36, v156
v_mov_b32 v37, v157
L_att_sl1:
s_lshl_b32 s52, s51, 8
v_add_u32 v8, s52, v24
v_add_u32 v9, s52, v25

ds_read_b64 v[40:41], v8 offset:0
ds_read_b64 v[42:43], v8 offset:4128
ds_read_b64 v[44:45], v9 offset:0
s_waitcnt lgkmcnt(0)
s_cmp_eq_u32 s51, 0
s_cbranch_scc1 L_att_slow_far
s_cmp_eq_u32 s51, 8
s_cbranch_scc1 L_att_slow_diag
v_mfma_f32_32x32x16_bf16 v[64:79], v[40:43], v[32:35], 0
v_mfma_f32_32x32x8_bf16 v[64:79], v[44:45], v[36:37], v[64:79]
s_branch L_att_slow_m
L_att_slow_far:
v_mfma_f32_32x32x16_bf16 v[64:79], v[40:43], v[32:35], v[136:151]
v_mfma_f32_32x32x8_bf16 v[64:79], v[44:45], v[36:37], v[64:79]
s_branch L_att_slow_m
L_att_slow_diag:
v_mfma_f32_32x32x16_bf16 v[64:79], v[40:43], v[32:35], v[120:135]
v_mfma_f32_32x32x8_bf16 v[64:79], v[44:45], v[36:37], v[64:79]
L_att_slow_m:
s_nop 15
v_max3_f32 v22, v22, v64, v65
v_max3_f32 v22, v22, v66, v67
v_max3_f32 v22, v22, v68, v69
v_max3_f32 v22, v22, v70, v71
v_max3_f32 v22, v22, v72, v73
v_max3_f32 v22, v22, v74, v75
v_max3_f32 v22, v22, v76, v77
v_max3_f32 v22, v22, v78, v79
s_add_u32 s51, s51, 1
s_cmp_le_u32 s51, 8
s_cbranch_scc1 L_att_slow
v_mov_b32 v8, v24
v_mov_b32 v9, v25
v_mov_b32 v104, 0
v_mov_b32 v105, 0
v_mov_b32 v106, 0
v_mov_b32 v107, 0
v_mov_b32 v108, 0
v_mov_b32 v109, 0
v_mov_b32 v110, 0
v_mov_b32 v111, 0
v_mov_b32 v112, 0
v_mov_b32 v113, 0
v_mov_b32 v114, 0
v_mov_b32 v115, 0
v_mov_b32 v116, 0
v_mov_b32 v117, 0
v_mov_b32 v118, 0
v_mov_b32 v119, 0
v_mov_b32 v23, v22
s_nop 1
v_permlane32_swap_b32 v22, v23
s_nop 1
v_max_f32 v22, v22, v23
s_cmp_eq_u32 s31, 0
s_cbranch_scc1 L_att_run
v_mov_b32 v23, v26
s_nop 1
v_permlane32_swap_b32 v26, v23
s_nop 1
v_max_f32 v26, v26, v23
v_mov_b32 v32, v176
v_mov_b32 v33, v177
v_mov_b32 v34, v178
v_mov_b32 v35, v179
v_mov_b32 v36, v180
v_mov_b32 v37, v181
s_branch L_att_run
L_att_fin:
s_cmp_eq_u32 s31, 0
s_cbranch_scc0 L_att_fin_p
v_rcp_f32 v20, v116
v_add_u32 v18, s43, v3
v_lshlrev_b32 v28, 4, v18
v_lshlrev_b32 v19, 15, v4
v_add_u32 v11, v19, v28
v_pk_mul_f32 v[104:105], v[104:105], v[20:21] op_sel_hi:[1,0]
v_pk_mul_f32 v[106:107], v[106:107], v[20:21] op_sel_hi:[1,0]
v_pk_mul_f32 v[108:109], v[108:109], v[20:21] op_sel_hi:[1,0]
v_pk_mul_f32 v[110:111], v[110:111], v[20:21] op_sel_hi:[1,0]
v_pk_mul_f32 v[112:113], v[112:113], v[20:21] op_sel_hi:[1,0]
v_pk_mul_f32 v[114:115], v[114:115], v[20:21] op_sel_hi:[1,0]
v_cvt_pk_bf16_f32 v96, v104, v105
v_cvt_pk_bf16_f32 v97, v106, v107
v_cvt_pk_bf16_f32 v98, v108, v109
v_cvt_pk_bf16_f32 v99, v110, v111
v_cvt_pk_bf16_f32 v100, v112, v113
v_cvt_pk_bf16_f32 v101, v114, v115
s_lshl_b32 s45, s42, 16
s_add_u32 s45, s45, 8388608
s_lshr_b32 s46, s42, 1
s_add_u32 s46, s46, 64
s_lshl_b32 s46, s46, 15
s_and_b32 s47, s42, 1
s_lshl_b32 s47, s47, 3
s_add_u32 s46, s46, s47
s_add_u32 s46, s46, 8388608
v_permlane32_swap_b32 v96, v98
v_permlane32_swap_b32 v97, v99
s_mov_b32 exec_hi, 0
buffer_store_dwordx2 v[100:101], v28, s[20:23], s46 offen sc1
s_mov_b64 exec, -1
buffer_store_dwordx4 v[96:99], v11, s[20:23], s45 offen sc1
s_lshl_b32 s46, s43, 2
s_lshl_b32 s47, s42, 2
s_add_u32 s46, s46, s47
s_add_u32 s100, s46, 11870208
s_waitcnt vmcnt(0)
v_mov_b32 v18, s26
s_mov_b64 exec, 1
buffer_store_dword v18, off, s[20:23], s100 sc1
s_mov_b64 exec, -1
s_branch L_att_done
L_att_fin_p:
v_rcp_f32 v20, v116
v_add_u32 v18, s79, v3
v_lshlrev_b32 v28, 4, v18
v_lshlrev_b32 v19, 15, v4
v_add_u32 v11, v19, v28
v_pk_mul_f32 v[104:105], v[104:105], v[20:21] op_sel_hi:[1,0]
v_pk_mul_f32 v[106:107], v[106:107], v[20:21] op_sel_hi:[1,0]
v_pk_mul_f32 v[108:109], v[108:109], v[20:21] op_sel_hi:[1,0]
v_pk_mul_f32 v[110:111], v[110:111], v[20:21] op_sel_hi:[1,0]
v_pk_mul_f32 v[112:113], v[112:113], v[20:21] op_sel_hi:[1,0]
v_pk_mul_f32 v[114:115], v[114:115], v[20:21] op_sel_hi:[1,0]
v_cvt_pk_bf16_f32 v96, v104, v105
v_cvt_pk_bf16_f32 v97, v106, v107
v_cvt_pk_bf16_f32 v98, v108, v109
v_cvt_pk_bf16_f32 v99, v110, v111
v_cvt_pk_bf16_f32 v100, v112, v113
v_cvt_pk_bf16_f32 v101, v114, v115
s_lshl_b32 s45, s78, 16
s_add_u32 s45, s45, 8388608
s_lshr_b32 s46, s78, 1
s_add_u32 s46, s46, 64
s_lshl_b32 s46, s46, 15
s_and_b32 s47, s78, 1
s_lshl_b32 s47, s47, 3
s_add_u32 s46, s46, s47
s_add_u32 s46, s46, 8388608
v_permlane32_swap_b32 v96, v98
v_permlane32_swap_b32 v97, v99
s_mov_b32 exec_hi, 0
buffer_store_dwordx2 v[100:101], v28, s[20:23], s46 offen sc1
s_mov_b64 exec, -1
buffer_store_dwordx4 v[96:99], v11, s[20:23], s45 offen sc1
s_lshl_b32 s46, s79, 2
s_lshl_b32 s47, s78, 2
s_add_u32 s46, s46, s47
s_add_u32 s101, s46, 11870208
s_nop 1
v_rcp_f32 v20, v172
v_add_u32 v18, s43, v3
v_lshlrev_b32 v28, 4, v18
v_lshlrev_b32 v19, 15, v4
v_add_u32 v11, v19, v28
v_pk_mul_f32 v[160:161], v[160:161], v[20:21] op_sel_hi:[1,0]
v_pk_mul_f32 v[162:163], v[162:163], v[20:21] op_sel_hi:[1,0]
v_pk_mul_f32 v[164:165], v[164:165], v[20:21] op_sel_hi:[1,0]
v_pk_mul_f32 v[166:167], v[166:167], v[20:21] op_sel_hi:[1,0]
v_pk_mul_f32 v[168:169], v[168:169], v[20:21] op_sel_hi:[1,0]
v_pk_mul_f32 v[170:171], v[170:171], v[20:21] op_sel_hi:[1,0]
v_cvt_pk_bf16_f32 v96, v160, v161
v_cvt_pk_bf16_f32 v97, v162, v163
v_cvt_pk_bf16_f32 v98, v164, v165
v_cvt_pk_bf16_f32 v99, v166, v167
v_cvt_pk_bf16_f32 v100, v168, v169
v_cvt_pk_bf16_f32 v101, v170, v171
s_lshl_b32 s45, s42, 16
s_add_u32 s45, s45, 8388608
s_lshr_b32 s46, s42, 1
s_add_u32 s46, s46, 64
s_lshl_b32 s46, s46, 15
s_and_b32 s47, s42, 1
s_lshl_b32 s47, s47, 3
s_add_u32 s46, s46, s47
s_add_u32 s46, s46, 8388608
v_permlane32_swap_b32 v96, v98
v_permlane32_swap_b32 v97, v99
s_mov_b32 exec_hi, 0
buffer_store_dwordx2 v[100:101], v28, s[20:23], s46 offen sc1
s_mov_b64 exec, -1
buffer_store_dwordx4 v[96:99], v11, s[20:23], s45 offen sc1
s_lshl_b32 s46, s43, 2
s_lshl_b32 s47, s42, 2
s_add_u32 s46, s46, s47
s_add_u32 s100, s46, 11870208
s_waitcnt vmcnt(0)
v_mov_b32 v18, s26
s_mov_b64 exec, 1
buffer_store_dword v18, off, s[20:23], s100 sc1
s_mov_b64 exec, -1
v_mov_b32 v18, s26
s_mov_b64 exec, 1
buffer_store_dword v18, off, s[20:23], s101 sc1
s_mov_b64 exec, -1
L_att_done:
s_branch L_g2
L_aux:

s_sub_u32 s31, s29, 30
s_lshl_b32 s32, s28, 1
s_add_u32 s31, s31, s32
s_lshl_b32 s32, s31, 7
s_lshl_b32 s33, s30, 4
s_add_u32 s32, s32, s33
v_lshrrev_b32 v3, 4, v2
v_and_b32 v4, 15, v2
v_lshlrev_b32 v5, 4, v4
v_add_u32 v6, s32, v3
v_mul_u32_u24 v6, 1280, v6
v_add_u32 v6, v6, v5

s_waitcnt lgkmcnt(0)
s_mov_b32 s20, s84
s_mov_b32 s21, s85
s_mov_b32 s22, 12582912
s_mov_b32 s23, 0x20000
s_mov_b32 s16, s82
s_mov_b32 s17, s83
s_mov_b32 s18, 256
s_mov_b32 s19, 0x20000
s_mov_b32 s4, s64
s_mov_b32 s5, s65
s_mov_b32 s6, 2621440
s_mov_b32 s7, 0x20000
s_mov_b32 s12, s72
s_mov_b32 s13, s73
s_mov_b32 s14, 1280
s_mov_b32 s15, 0x20000
s_mov_b32 s40, 0
buffer_load_dwordx4 v[40:43], v6, s[4:7], s40 offen offset:0
buffer_load_dwordx4 v[44:47], v6, s[4:7], s40 offen offset:256
buffer_load_dwordx4 v[48:51], v6, s[4:7], s40 offen offset:512
buffer_load_dwordx4 v[52:55], v6, s[4:7], s40 offen offset:768
buffer_load_dwordx4 v[56:59], v6, s[4:7], s40 offen offset:1024
buffer_load_dwordx4 v[16:19], v5, s[12:15], 0 offen offset:0
buffer_load_dwordx4 v[20:23], v5, s[12:15], 0 offen offset:256
buffer_load_dwordx4 v[24:27], v5, s[12:15], 0 offen offset:512
buffer_load_dwordx4 v[28:31], v5, s[12:15], 0 offen offset:768
buffer_load_dwordx4 v[32:35], v5, s[12:15], 0 offen offset:1024
s_mov_b32 s40, 5120
buffer_load_dwordx4 v[60:63], v6, s[4:7], s40 offen offset:0
buffer_load_dwordx4 v[64:67], v6, s[4:7], s40 offen offset:256
buffer_load_dwordx4 v[68:71], v6, s[4:7], s40 offen offset:512
buffer_load_dwordx4 v[72:75], v6, s[4:7], s40 offen offset:768
buffer_load_dwordx4 v[76:79], v6, s[4:7], s40 offen offset:1024
s_mov_b32 s40, 10240
buffer_load_dwordx4 v[80:83], v6, s[4:7], s40 offen offset:0
buffer_load_dwordx4 v[84:87], v6, s[4:7], s40 offen offset:256
buffer_load_dwordx4 v[88:91], v6, s[4:7], s40 offen offset:512
buffer_load_dwordx4 v[92:95], v6, s[4:7], s40 offen offset:768
buffer_load_dwordx4 v[96:99], v6, s[4:7], s40 offen offset:1024
s_mov_b32 s40, 15360
buffer_load_dwordx4 v[100:103], v6, s[4:7], s40 offen offset:0
buffer_load_dwordx4 v[104:107], v6, s[4:7], s40 offen offset:256
buffer_load_dwordx4 v[108:111], v6, s[4:7], s40 offen offset:512
buffer_load_dwordx4 v[112:115], v6, s[4:7], s40 offen offset:768
buffer_load_dwordx4 v[116:119], v6, s[4:7], s40 offen offset:1024
s_mov_b32 s43, 0x3f803f80
v_mov_b32 v8, 0
v_mov_b32 v9, 0
v_mov_b32 v10, 0
v_mov_b32 v11, 0
s_waitcnt vmcnt(15)
v_dot2c_f32_bf16 v11, s43, v16
v_dot2c_f32_bf16 v11, s43, v17
v_dot2c_f32_bf16 v11, s43, v18
v_dot2c_f32_bf16 v11, s43, v19
v_dot2c_f32_bf16 v11, s43, v20
v_dot2c_f32_bf16 v11, s43, v21
v_dot2c_f32_bf16 v11, s43, v22
v_dot2c_f32_bf16 v11, s43, v23
v_dot2c_f32_bf16 v11, s43, v24
v_dot2c_f32_bf16 v11, s43, v25
v_dot2c_f32_bf16 v11, s43, v26
v_dot2c_f32_bf16 v11, s43, v27
v_dot2c_f32_bf16 v11, s43, v28
v_dot2c_f32_bf16 v11, s43, v29
v_dot2c_f32_bf16 v11, s43, v30
v_dot2c_f32_bf16 v11, s43, v31
v_dot2c_f32_bf16 v11, s43, v32
v_dot2c_f32_bf16 v11, s43, v33
v_dot2c_f32_bf16 v11, s43, v34
v_dot2c_f32_bf16 v11, s43, v35
s_nop 2
v_add_f32_dpp v11, v11, v11 row_ror:8 row_mask:0xf bank_mask:0xf
s_nop 2
v_add_f32_dpp v11, v11, v11 row_ror:4 row_mask:0xf bank_mask:0xf
s_nop 2
v_add_f32_dpp v11, v11, v11 row_ror:2 row_mask:0xf bank_mask:0xf
s_nop 2
v_add_f32_dpp v11, v11, v11 row_ror:1 row_mask:0xf bank_mask:0xf
s_waitcnt vmcnt(15)
v_mov_b32 v12, 0
v_mov_b32 v13, 0
v_mov_b32 v14, 0
v_dot2c_f32_bf16 v12, s43, v40
v_dot2c_f32_bf16 v13, v40, v40
v_dot2c_f32_bf16 v14, v40, v16
v_dot2c_f32_bf16 v12, s43, v41
v_dot2c_f32_bf16 v13, v41, v41
v_dot2c_f32_bf16 v14, v41, v17
v_dot2c_f32_bf16 v12, s43, v42
v_dot2c_f32_bf16 v13, v42, v42
v_dot2c_f32_bf16 v14, v42, v18
v_dot2c_f32_bf16 v12, s43, v43
v_dot2c_f32_bf16 v13, v43, v43
v_dot2c_f32_bf16 v14, v43, v19
v_dot2c_f32_bf16 v12, s43, v44
v_dot2c_f32_bf16 v13, v44, v44
v_dot2c_f32_bf16 v14, v44, v20
v_dot2c_f32_bf16 v12, s43, v45
v_dot2c_f32_bf16 v13, v45, v45
v_dot2c_f32_bf16 v14, v45, v21
v_dot2c_f32_bf16 v12, s43, v46
v_dot2c_f32_bf16 v13, v46, v46
v_dot2c_f32_bf16 v14, v46, v22
v_dot2c_f32_bf16 v12, s43, v47
v_dot2c_f32_bf16 v13, v47, v47
v_dot2c_f32_bf16 v14, v47, v23
v_dot2c_f32_bf16 v12, s43, v48
v_dot2c_f32_bf16 v13, v48, v48
v_dot2c_f32_bf16 v14, v48, v24
v_dot2c_f32_bf16 v12, s43, v49
v_dot2c_f32_bf16 v13, v49, v49
v_dot2c_f32_bf16 v14, v49, v25
v_dot2c_f32_bf16 v12, s43, v50
v_dot2c_f32_bf16 v13, v50, v50
v_dot2c_f32_bf16 v14, v50, v26
v_dot2c_f32_bf16 v12, s43, v51
v_dot2c_f32_bf16 v13, v51, v51
v_dot2c_f32_bf16 v14, v51, v27
v_dot2c_f32_bf16 v12, s43, v52
v_dot2c_f32_bf16 v13, v52, v52
v_dot2c_f32_bf16 v14, v52, v28
v_dot2c_f32_bf16 v12, s43, v53
v_dot2c_f32_bf16 v13, v53, v53
v_dot2c_f32_bf16 v14, v53, v29
v_dot2c_f32_bf16 v12, s43, v54
v_dot2c_f32_bf16 v13, v54, v54
v_dot2c_f32_bf16 v14, v54, v30
v_dot2c_f32_bf16 v12, s43, v55
v_dot2c_f32_bf16 v13, v55, v55
v_dot2c_f32_bf16 v14, v55, v31
v_dot2c_f32_bf16 v12, s43, v56
v_dot2c_f32_bf16 v13, v56, v56
v_dot2c_f32_bf16 v14, v56, v32
v_dot2c_f32_bf16 v12, s43, v57
v_dot2c_f32_bf16 v13, v57, v57
v_dot2c_f32_bf16 v14, v57, v33
v_dot2c_f32_bf16 v12, s43, v58
v_dot2c_f32_bf16 v13, v58, v58
v_dot2c_f32_bf16 v14, v58, v34
v_dot2c_f32_bf16 v12, s43, v59
v_dot2c_f32_bf16 v13, v59, v59
v_dot2c_f32_bf16 v14, v59, v35
s_nop 2
v_add_f32_dpp v12, v12, v12 row_ror:8 row_mask:0xf bank_mask:0xf
v_add_f32_dpp v13, v13, v13 row_ror:8 row_mask:0xf bank_mask:0xf
v_add_f32_dpp v14, v14, v14 row_ror:8 row_mask:0xf bank_mask:0xf
s_nop 2
v_add_f32_dpp v12, v12, v12 row_ror:4 row_mask:0xf bank_mask:0xf
v_add_f32_dpp v13, v13, v13 row_ror:4 row_mask:0xf bank_mask:0xf
v_add_f32_dpp v14, v14, v14 row_ror:4 row_mask:0xf bank_mask:0xf
s_nop 2
v_add_f32_dpp v12, v12, v12 row_ror:2 row_mask:0xf bank_mask:0xf
v_add_f32_dpp v13, v13, v13 row_ror:2 row_mask:0xf bank_mask:0xf
v_add_f32_dpp v14, v14, v14 row_ror:2 row_mask:0xf bank_mask:0xf
s_nop 2
v_add_f32_dpp v12, v12, v12 row_ror:1 row_mask:0xf bank_mask:0xf
v_add_f32_dpp v13, v13, v13 row_ror:1 row_mask:0xf bank_mask:0xf
v_add_f32_dpp v14, v14, v14 row_ror:1 row_mask:0xf bank_mask:0xf
v_cmp_eq_u32 vcc, 0, v4
s_nop 1
v_cndmask_b32 v8, v8, v12, vcc
v_cndmask_b32 v9, v9, v13, vcc
v_cndmask_b32 v10, v10, v14, vcc
s_waitcnt vmcnt(10)
v_mov_b32 v12, 0
v_mov_b32 v13, 0
v_mov_b32 v14, 0
v_dot2c_f32_bf16 v12, s43, v60
v_dot2c_f32_bf16 v13, v60, v60
v_dot2c_f32_bf16 v14, v60, v16
v_dot2c_f32_bf16 v12, s43, v61
v_dot2c_f32_bf16 v13, v61, v61
v_dot2c_f32_bf16 v14, v61, v17
v_dot2c_f32_bf16 v12, s43, v62
v_dot2c_f32_bf16 v13, v62, v62
v_dot2c_f32_bf16 v14, v62, v18
v_dot2c_f32_bf16 v12, s43, v63
v_dot2c_f32_bf16 v13, v63, v63
v_dot2c_f32_bf16 v14, v63, v19
v_dot2c_f32_bf16 v12, s43, v64
v_dot2c_f32_bf16 v13, v64, v64
v_dot2c_f32_bf16 v14, v64, v20
v_dot2c_f32_bf16 v12, s43, v65
v_dot2c_f32_bf16 v13, v65, v65
v_dot2c_f32_bf16 v14, v65, v21
v_dot2c_f32_bf16 v12, s43, v66
v_dot2c_f32_bf16 v13, v66, v66
v_dot2c_f32_bf16 v14, v66, v22
v_dot2c_f32_bf16 v12, s43, v67
v_dot2c_f32_bf16 v13, v67, v67
v_dot2c_f32_bf16 v14, v67, v23
v_dot2c_f32_bf16 v12, s43, v68
v_dot2c_f32_bf16 v13, v68, v68
v_dot2c_f32_bf16 v14, v68, v24
v_dot2c_f32_bf16 v12, s43, v69
v_dot2c_f32_bf16 v13, v69, v69
v_dot2c_f32_bf16 v14, v69, v25
v_dot2c_f32_bf16 v12, s43, v70
v_dot2c_f32_bf16 v13, v70, v70
v_dot2c_f32_bf16 v14, v70, v26
v_dot2c_f32_bf16 v12, s43, v71
v_dot2c_f32_bf16 v13, v71, v71
v_dot2c_f32_bf16 v14, v71, v27
v_dot2c_f32_bf16 v12, s43, v72
v_dot2c_f32_bf16 v13, v72, v72
v_dot2c_f32_bf16 v14, v72, v28
v_dot2c_f32_bf16 v12, s43, v73
v_dot2c_f32_bf16 v13, v73, v73
v_dot2c_f32_bf16 v14, v73, v29
v_dot2c_f32_bf16 v12, s43, v74
v_dot2c_f32_bf16 v13, v74, v74
v_dot2c_f32_bf16 v14, v74, v30
v_dot2c_f32_bf16 v12, s43, v75
v_dot2c_f32_bf16 v13, v75, v75
v_dot2c_f32_bf16 v14, v75, v31
v_dot2c_f32_bf16 v12, s43, v76
v_dot2c_f32_bf16 v13, v76, v76
v_dot2c_f32_bf16 v14, v76, v32
v_dot2c_f32_bf16 v12, s43, v77
v_dot2c_f32_bf16 v13, v77, v77
v_dot2c_f32_bf16 v14, v77, v33
v_dot2c_f32_bf16 v12, s43, v78
v_dot2c_f32_bf16 v13, v78, v78
v_dot2c_f32_bf16 v14, v78, v34
v_dot2c_f32_bf16 v12, s43, v79
v_dot2c_f32_bf16 v13, v79, v79
v_dot2c_f32_bf16 v14, v79, v35
s_nop 2
v_add_f32_dpp v12, v12, v12 row_ror:8 row_mask:0xf bank_mask:0xf
v_add_f32_dpp v13, v13, v13 row_ror:8 row_mask:0xf bank_mask:0xf
v_add_f32_dpp v14, v14, v14 row_ror:8 row_mask:0xf bank_mask:0xf
s_nop 2
v_add_f32_dpp v12, v12, v12 row_ror:4 row_mask:0xf bank_mask:0xf
v_add_f32_dpp v13, v13, v13 row_ror:4 row_mask:0xf bank_mask:0xf
v_add_f32_dpp v14, v14, v14 row_ror:4 row_mask:0xf bank_mask:0xf
s_nop 2
v_add_f32_dpp v12, v12, v12 row_ror:2 row_mask:0xf bank_mask:0xf
v_add_f32_dpp v13, v13, v13 row_ror:2 row_mask:0xf bank_mask:0xf
v_add_f32_dpp v14, v14, v14 row_ror:2 row_mask:0xf bank_mask:0xf
s_nop 2
v_add_f32_dpp v12, v12, v12 row_ror:1 row_mask:0xf bank_mask:0xf
v_add_f32_dpp v13, v13, v13 row_ror:1 row_mask:0xf bank_mask:0xf
v_add_f32_dpp v14, v14, v14 row_ror:1 row_mask:0xf bank_mask:0xf
v_cmp_eq_u32 vcc, 1, v4
s_nop 1
v_cndmask_b32 v8, v8, v12, vcc
v_cndmask_b32 v9, v9, v13, vcc
v_cndmask_b32 v10, v10, v14, vcc
s_waitcnt vmcnt(5)
v_mov_b32 v12, 0
v_mov_b32 v13, 0
v_mov_b32 v14, 0
v_dot2c_f32_bf16 v12, s43, v80
v_dot2c_f32_bf16 v13, v80, v80
v_dot2c_f32_bf16 v14, v80, v16
v_dot2c_f32_bf16 v12, s43, v81
v_dot2c_f32_bf16 v13, v81, v81
v_dot2c_f32_bf16 v14, v81, v17
v_dot2c_f32_bf16 v12, s43, v82
v_dot2c_f32_bf16 v13, v82, v82
v_dot2c_f32_bf16 v14, v82, v18
v_dot2c_f32_bf16 v12, s43, v83
v_dot2c_f32_bf16 v13, v83, v83
v_dot2c_f32_bf16 v14, v83, v19
v_dot2c_f32_bf16 v12, s43, v84
v_dot2c_f32_bf16 v13, v84, v84
v_dot2c_f32_bf16 v14, v84, v20
v_dot2c_f32_bf16 v12, s43, v85
v_dot2c_f32_bf16 v13, v85, v85
v_dot2c_f32_bf16 v14, v85, v21
v_dot2c_f32_bf16 v12, s43, v86
v_dot2c_f32_bf16 v13, v86, v86
v_dot2c_f32_bf16 v14, v86, v22
v_dot2c_f32_bf16 v12, s43, v87
v_dot2c_f32_bf16 v13, v87, v87
v_dot2c_f32_bf16 v14, v87, v23
v_dot2c_f32_bf16 v12, s43, v88
v_dot2c_f32_bf16 v13, v88, v88
v_dot2c_f32_bf16 v14, v88, v24
v_dot2c_f32_bf16 v12, s43, v89
v_dot2c_f32_bf16 v13, v89, v89
v_dot2c_f32_bf16 v14, v89, v25
v_dot2c_f32_bf16 v12, s43, v90
v_dot2c_f32_bf16 v13, v90, v90
v_dot2c_f32_bf16 v14, v90, v26
v_dot2c_f32_bf16 v12, s43, v91
v_dot2c_f32_bf16 v13, v91, v91
v_dot2c_f32_bf16 v14, v91, v27
v_dot2c_f32_bf16 v12, s43, v92
v_dot2c_f32_bf16 v13, v92, v92
v_dot2c_f32_bf16 v14, v92, v28
v_dot2c_f32_bf16 v12, s43, v93
v_dot2c_f32_bf16 v13, v93, v93
v_dot2c_f32_bf16 v14, v93, v29
v_dot2c_f32_bf16 v12, s43, v94
v_dot2c_f32_bf16 v13, v94, v94
v_dot2c_f32_bf16 v14, v94, v30
v_dot2c_f32_bf16 v12, s43, v95
v_dot2c_f32_bf16 v13, v95, v95
v_dot2c_f32_bf16 v14, v95, v31
v_dot2c_f32_bf16 v12, s43, v96
v_dot2c_f32_bf16 v13, v96, v96
v_dot2c_f32_bf16 v14, v96, v32
v_dot2c_f32_bf16 v12, s43, v97
v_dot2c_f32_bf16 v13, v97, v97
v_dot2c_f32_bf16 v14, v97, v33
v_dot2c_f32_bf16 v12, s43, v98
v_dot2c_f32_bf16 v13, v98, v98
v_dot2c_f32_bf16 v14, v98, v34
v_dot2c_f32_bf16 v12, s43, v99
v_dot2c_f32_bf16 v13, v99, v99
v_dot2c_f32_bf16 v14, v99, v35
s_nop 2
v_add_f32_dpp v12, v12, v12 row_ror:8 row_mask:0xf bank_mask:0xf
v_add_f32_dpp v13, v13, v13 row_ror:8 row_mask:0xf bank_mask:0xf
v_add_f32_dpp v14, v14, v14 row_ror:8 row_mask:0xf bank_mask:0xf
s_nop 2
v_add_f32_dpp v12, v12, v12 row_ror:4 row_mask:0xf bank_mask:0xf
v_add_f32_dpp v13, v13, v13 row_ror:4 row_mask:0xf bank_mask:0xf
v_add_f32_dpp v14, v14, v14 row_ror:4 row_mask:0xf bank_mask:0xf
s_nop 2
v_add_f32_dpp v12, v12, v12 row_ror:2 row_mask:0xf bank_mask:0xf
v_add_f32_dpp v13, v13, v13 row_ror:2 row_mask:0xf bank_mask:0xf
v_add_f32_dpp v14, v14, v14 row_ror:2 row_mask:0xf bank_mask:0xf
s_nop 2
v_add_f32_dpp v12, v12, v12 row_ror:1 row_mask:0xf bank_mask:0xf
v_add_f32_dpp v13, v13, v13 row_ror:1 row_mask:0xf bank_mask:0xf
v_add_f32_dpp v14, v14, v14 row_ror:1 row_mask:0xf bank_mask:0xf
v_cmp_eq_u32 vcc, 2, v4
s_nop 1
v_cndmask_b32 v8, v8, v12, vcc
v_cndmask_b32 v9, v9, v13, vcc
v_cndmask_b32 v10, v10, v14, vcc
s_waitcnt vmcnt(0)
buffer_load_dword v39, off, s[16:19], 0 sc1
v_mov_b32 v12, 0
v_mov_b32 v13, 0
v_mov_b32 v14, 0
v_dot2c_f32_bf16 v12, s43, v100
v_dot2c_f32_bf16 v13, v100, v100
v_dot2c_f32_bf16 v14, v100, v16
v_dot2c_f32_bf16 v12, s43, v101
v_dot2c_f32_bf16 v13, v101, v101
v_dot2c_f32_bf16 v14, v101, v17
v_dot2c_f32_bf16 v12, s43, v102
v_dot2c_f32_bf16 v13, v102, v102
v_dot2c_f32_bf16 v14, v102, v18
v_dot2c_f32_bf16 v12, s43, v103
v_dot2c_f32_bf16 v13, v103, v103
v_dot2c_f32_bf16 v14, v103, v19
v_dot2c_f32_bf16 v12, s43, v104
v_dot2c_f32_bf16 v13, v104, v104
v_dot2c_f32_bf16 v14, v104, v20
v_dot2c_f32_bf16 v12, s43, v105
v_dot2c_f32_bf16 v13, v105, v105
v_dot2c_f32_bf16 v14, v105, v21
v_dot2c_f32_bf16 v12, s43, v106
v_dot2c_f32_bf16 v13, v106, v106
v_dot2c_f32_bf16 v14, v106, v22
v_dot2c_f32_bf16 v12, s43, v107
v_dot2c_f32_bf16 v13, v107, v107
v_dot2c_f32_bf16 v14, v107, v23
v_dot2c_f32_bf16 v12, s43, v108
v_dot2c_f32_bf16 v13, v108, v108
v_dot2c_f32_bf16 v14, v108, v24
v_dot2c_f32_bf16 v12, s43, v109
v_dot2c_f32_bf16 v13, v109, v109
v_dot2c_f32_bf16 v14, v109, v25
v_dot2c_f32_bf16 v12, s43, v110
v_dot2c_f32_bf16 v13, v110, v110
v_dot2c_f32_bf16 v14, v110, v26
v_dot2c_f32_bf16 v12, s43, v111
v_dot2c_f32_bf16 v13, v111, v111
v_dot2c_f32_bf16 v14, v111, v27
v_dot2c_f32_bf16 v12, s43, v112
v_dot2c_f32_bf16 v13, v112, v112
v_dot2c_f32_bf16 v14, v112, v28
v_dot2c_f32_bf16 v12, s43, v113
v_dot2c_f32_bf16 v13, v113, v113
v_dot2c_f32_bf16 v14, v113, v29
v_dot2c_f32_bf16 v12, s43, v114
v_dot2c_f32_bf16 v13, v114, v114
v_dot2c_f32_bf16 v14, v114, v30
v_dot2c_f32_bf16 v12, s43, v115
v_dot2c_f32_bf16 v13, v115, v115
v_dot2c_f32_bf16 v14, v115, v31
v_dot2c_f32_bf16 v12, s43, v116
v_dot2c_f32_bf16 v13, v116, v116
v_dot2c_f32_bf16 v14, v116, v32
v_dot2c_f32_bf16 v12, s43, v117
v_dot2c_f32_bf16 v13, v117, v117
v_dot2c_f32_bf16 v14, v117, v33
v_dot2c_f32_bf16 v12, s43, v118
v_dot2c_f32_bf16 v13, v118, v118
v_dot2c_f32_bf16 v14, v118, v34
v_dot2c_f32_bf16 v12, s43, v119
v_dot2c_f32_bf16 v13, v119, v119
v_dot2c_f32_bf16 v14, v119, v35
s_nop 2
v_add_f32_dpp v12, v12, v12 row_ror:8 row_mask:0xf bank_mask:0xf
v_add_f32_dpp v13, v13, v13 row_ror:8 row_mask:0xf bank_mask:0xf
v_add_f32_dpp v14, v14, v14 row_ror:8 row_mask:0xf bank_mask:0xf
s_nop 2
v_add_f32_dpp v12, v12, v12 row_ror:4 row_mask:0xf bank_mask:0xf
v_add_f32_dpp v13, v13, v13 row_ror:4 row_mask:0xf bank_mask:0xf
v_add_f32_dpp v14, v14, v14 row_ror:4 row_mask:0xf bank_mask:0xf
s_nop 2
v_add_f32_dpp v12, v12, v12 row_ror:2 row_mask:0xf bank_mask:0xf
v_add_f32_dpp v13, v13, v13 row_ror:2 row_mask:0xf bank_mask:0xf
v_add_f32_dpp v14, v14, v14 row_ror:2 row_mask:0xf bank_mask:0xf
s_nop 2
v_add_f32_dpp v12, v12, v12 row_ror:1 row_mask:0xf bank_mask:0xf
v_add_f32_dpp v13, v13, v13 row_ror:1 row_mask:0xf bank_mask:0xf
v_add_f32_dpp v14, v14, v14 row_ror:1 row_mask:0xf bank_mask:0xf
v_cmp_eq_u32 vcc, 3, v4
s_nop 1
v_cndmask_b32 v8, v8, v12, vcc
v_cndmask_b32 v9, v9, v13, vcc
v_cndmask_b32 v10, v10, v14, vcc
v_mul_f32 v14, 0x3acccccd, v8
v_mul_f32 v15, 0x3acccccd, v9
v_fma_f32 v15, -v14, v14, v15
v_max_f32 v15, 0, v15
v_cvt_pk_bf16_f32 v12, v14, v15
v_and_b32 v15, 0xffff0000, v12
v_lshlrev_b32 v12, 16, v12
v_add_f32 v15, 0x3727c5ac, v15
v_cvt_pk_bf16_f32 v15, v15, v15
v_lshlrev_b32 v15, 16, v15
v_sqrt_f32 v15, v15
s_nop 0
v_cvt_pk_bf16_f32 v15, v15, v15
v_lshlrev_b32 v15, 16, v15
v_rcp_f32 v13, v15
s_nop 0

v_fma_f32 v10, -v12, v11, v10
v_mul_f32 v10, v10, v13
v_cvt_pk_bf16_f32 v10, v10, v10
v_lshlrev_b32 v14, 16, v10
v_lshlrev_b32 v5, 2, v4
v_add_u32 v5, v5, v3
v_add_u32 v5, s32, v5
v_ashrrev_i32 v20, 31, v14
v_or_b32 v20, 0x80000000, v20
v_xor_b32 v20, v14, v20
v_and_b32 v20, 0xffff0000, v20
v_sub_u32 v21, 0x7ff, v5
v_or_b32 v20, v20, v21
v_cmp_gt_u32 vcc, 4, v4
v_lshlrev_b32 v5, 4, v5
s_waitcnt vmcnt(0)
v_cndmask_b32 v20, 0, v20, vcc
v_readfirstlane_b32 s26, v39
s_nop 3
s_cmp_lg_u32 s26, 0
s_cbranch_scc1 L_aux_gotn

s_mov_b32 s27, 0x20000
L_gn16:
buffer_load_dword v15, off, s[16:19], 0 sc1
s_waitcnt vmcnt(0)
v_readfirstlane_b32 s26, v15
s_sub_u32 s27, s27, 1
s_cmp_lg_u32 s26, 0
s_cbranch_scc1 L_gnd16
s_sleep 1
s_cmp_lg_u32 s27, 0
s_cbranch_scc1 L_gn16
L_gnd16:
L_aux_gotn:
v_mov_b32 v15, s26
v_cmp_gt_u32 vcc, 4, v4
s_mov_b32 s40, 11534336
v_mov_b32 v21, v20
s_nop 2
s_and_saveexec_b64 s[60:61], vcc
buffer_store_dwordx4 v[12:15], v5, s[20:23], s40 offen sc1
s_mov_b64 exec, s[60:61]

s_nop 1
v_max_u32_dpp v21, v21, v21 row_shr:1 row_mask:0xf bank_mask:0xf bound_ctrl:0
s_nop 1
v_max_u32_dpp v21, v21, v21 row_shr:2 row_mask:0xf bank_mask:0xf bound_ctrl:0
s_nop 1
v_max_u32_dpp v21, v21, v21 row_shr:4 row_mask:0xf bank_mask:0xf bound_ctrl:0
s_nop 1
v_max_u32_dpp v21, v21, v21 row_shr:8 row_mask:0xf bank_mask:0xf bound_ctrl:0
s_nop 1
v_max_u32_dpp v21, v21, v21 row_bcast:15 row_mask:0xa bank_mask:0xf
s_nop 1
v_max_u32_dpp v21, v21, v21 row_bcast:31 row_mask:0xc bank_mask:0xf
s_nop 1
v_readlane_b32 s56, v21, 63
s_nop 3
v_cmp_ne_u32 vcc, s56, v20
s_nop 1
v_cndmask_b32 v20, 0, v20, vcc
s_nop 1
v_max_u32_dpp v20, v20, v20 row_shr:1 row_mask:0xf bank_mask:0xf bound_ctrl:0
s_nop 1
v_max_u32_dpp v20, v20, v20 row_shr:2 row_mask:0xf bank_mask:0xf bound_ctrl:0
s_nop 1
v_max_u32_dpp v20, v20, v20 row_shr:4 row_mask:0xf bank_mask:0xf bound_ctrl:0
s_nop 1
v_max_u32_dpp v20, v20, v20 row_shr:8 row_mask:0xf bank_mask:0xf bound_ctrl:0
s_nop 1
v_max_u32_dpp v20, v20, v20 row_bcast:15 row_mask:0xa bank_mask:0xf
s_nop 1
v_max_u32_dpp v20, v20, v20 row_bcast:31 row_mask:0xc bank_mask:0xf
s_nop 1
v_readlane_b32 s57, v20, 63
v_mov_b32 v24, s56
v_mov_b32 v26, s26
v_mov_b32 v27, 0
s_lshl_b32 s40, s31, 3
s_add_u32 s40, s40, s30
s_lshl_b32 s40, s40, 4
s_add_u32 s40, s40, 11796480
v_mov_b32 v25, s57
s_waitcnt vmcnt(0)
s_mov_b64 exec, 1
buffer_store_dwordx4 v[24:27], off, s[20:23], s40 sc1
s_mov_b64 exec, -1

s_barrier

s_cmp_ge_u32 s30, 4
s_cselect_b32 s8, s76, s74
s_cselect_b32 s9, s77, s75
s_mov_b32 s10, 1966080
s_mov_b32 s11, 0x20000
v_lshlrev_b32 v5, 4, v4
v_mul_u32_u24 v7, 24576, v3
v_add_u32 v7, v7, v5
s_mul_i32 s34, s31, 192
v_add_u32 v7, s34, v7
v_mov_b32 v8, -1
v_cmp_gt_u32 vcc, 12, v4
s_and_b32 s33, s30, 3
s_mul_i32 s34, s33, 491520
v_cndmask_b32 v7, v8, v7, vcc

s_cmp_eq_u32 s30, 7
s_cbranch_scc1 L_ax_poll
s_add_u32 s35, s34, 0
buffer_load_dwordx4 v[88:91], v7, s[8:11], s35 offen
s_add_u32 s35, s34, 3072
buffer_load_dwordx4 v[92:95], v7, s[8:11], s35 offen
s_add_u32 s35, s34, 6144
buffer_load_dwordx4 v[96:99], v7, s[8:11], s35 offen
s_add_u32 s35, s34, 9216
buffer_load_dwordx4 v[100:103], v7, s[8:11], s35 offen
s_add_u32 s35, s34, 12288
buffer_load_dwordx4 v[104:107], v7, s[8:11], s35 offen
s_add_u32 s35, s34, 15360
buffer_load_dwordx4 v[108:111], v7, s[8:11], s35 offen
s_add_u32 s35, s34, 18432
buffer_load_dwordx4 v[112:115], v7, s[8:11], s35 offen
s_add_u32 s35, s34, 21504
buffer_load_dwordx4 v[116:119], v7, s[8:11], s35 offen
s_add_u32 s35, s34, 98304
buffer_load_dwordx4 v[120:123], v7, s[8:11], s35 offen
s_add_u32 s35, s34, 101376
buffer_load_dwordx4 v[124:127], v7, s[8:11], s35 offen
s_add_u32 s35, s34, 104448
buffer_load_dwordx4 v[128:131], v7, s[8:11], s35 offen
s_add_u32 s35, s34, 107520
buffer_load_dwordx4 v[132:135], v7, s[8:11], s35 offen
s_add_u32 s35, s34, 110592
buffer_load_dwordx4 v[136:139], v7, s[8:11], s35 offen
s_add_u32 s35, s34, 113664
buffer_load_dwordx4 v[140:143], v7, s[8:11], s35 offen
s_add_u32 s35, s34, 116736
buffer_load_dwordx4 v[144:147], v7, s[8:11], s35 offen
s_add_u32 s35, s34, 119808
buffer_load_dwordx4 v[148:151], v7, s[8:11], s35 offen
s_add_u32 s35, s34, 196608
buffer_load_dwordx4 v[152:155], v7, s[8:11], s35 offen
s_add_u32 s35, s34, 199680
buffer_load_dwordx4 v[156:159], v7, s[8:11], s35 offen
s_add_u32 s35, s34, 202752
buffer_load_dwordx4 v[160:163], v7, s[8:11], s35 offen
s_add_u32 s35, s34, 205824
buffer_load_dwordx4 v[164:167], v7, s[8:11], s35 offen
s_add_u32 s35, s34, 208896
buffer_load_dwordx4 v[168:171], v7, s[8:11], s35 offen
s_add_u32 s35, s34, 211968
buffer_load_dwordx4 v[172:175], v7, s[8:11], s35 offen
s_add_u32 s35, s34, 215040
buffer_load_dwordx4 v[176:179], v7, s[8:11], s35 offen
s_add_u32 s35, s34, 218112
buffer_load_dwordx4 v[180:183], v7, s[8:11], s35 offen
s_barrier
v_mov_b32 v8, 0
ds_read_b128 v[72:75], v8
s_waitcnt lgkmcnt(0)
v_readfirstlane_b32 s70, v72
v_readfirstlane_b32 s71, v73
v_readfirstlane_b32 s72, v74
v_readfirstlane_b32 s73, v75
s_branch L_ax_j
L_ax_poll:
v_lshlrev_b32 v80, 5, v2
s_mov_b32 s55, 11796480
buffer_load_dwordx4 v[72:75], v80, s[20:23], s55 offen sc1
buffer_load_dwordx4 v[76:79], v80, s[20:23], s55 offen offset:16 sc1
s_mov_b32 s27, 0x20000
s_waitcnt vmcnt(0)
L_gt17:
v_cmp_eq_u32 vcc, s26, v74
v_cmp_eq_u32 s[56:57], s26, v78
s_sub_u32 s27, s27, 1
s_nop 3
s_and_b64 vcc, vcc, s[56:57]
s_cmp_eq_u64 vcc, -1
s_cbranch_scc1 L_gtd17
s_cmp_eq_u32 s27, 0
s_cbranch_scc1 L_gtd17
s_sleep 2
v_lshlrev_b32 v80, 5, v2
s_mov_b32 s55, 11796480
buffer_load_dwordx4 v[72:75], v80, s[20:23], s55 offen sc1
buffer_load_dwordx4 v[76:79], v80, s[20:23], s55 offen offset:16 sc1
s_waitcnt vmcnt(0)
s_branch L_gt17
L_gtd17:
v_max_u32 v81, v72, v76
s_nop 1
v_max_u32_dpp v81, v81, v81 row_shr:1 row_mask:0xf bank_mask:0xf bound_ctrl:0
s_nop 1
v_max_u32_dpp v81, v81, v81 row_shr:2 row_mask:0xf bank_mask:0xf bound_ctrl:0
s_nop 1
v_max_u32_dpp v81, v81, v81 row_shr:4 row_mask:0xf bank_mask:0xf bound_ctrl:0
s_nop 1
v_max_u32_dpp v81, v81, v81 row_shr:8 row_mask:0xf bank_mask:0xf bound_ctrl:0
s_nop 1
v_max_u32_dpp v81, v81, v81 row_bcast:15 row_mask:0xa bank_mask:0xf
s_nop 1
v_max_u32_dpp v81, v81, v81 row_bcast:31 row_mask:0xc bank_mask:0xf
s_nop 1
v_readlane_b32 s72, v81, 63
s_nop 3
v_cmp_ne_u32 vcc, s72, v72
v_cmp_ne_u32 s[56:57], s72, v76
s_nop 0
v_cndmask_b32 v72, v73, v72, vcc
v_cndmask_b32 v76, v77, v76, s[56:57]
v_max_u32 v81, v72, v76
s_nop 1
v_max_u32_dpp v81, v81, v81 row_shr:1 row_mask:0xf bank_mask:0xf bound_ctrl:0
s_nop 1
v_max_u32_dpp v81, v81, v81 row_shr:2 row_mask:0xf bank_mask:0xf bound_ctrl:0
s_nop 1
v_max_u32_dpp v81, v81, v81 row_shr:4 row_mask:0xf bank_mask:0xf bound_ctrl:0
s_nop 1
v_max_u32_dpp v81, v81, v81 row_shr:8 row_mask:0xf bank_mask:0xf bound_ctrl:0
s_nop 1
v_max_u32_dpp v81, v81, v81 row_bcast:15 row_mask:0xa bank_mask:0xf
s_nop 1
v_max_u32_dpp v81, v81, v81 row_bcast:31 row_mask:0xc bank_mask:0xf
s_nop 1
v_readlane_b32 s73, v81, 63
s_and_b32 s70, s72, 0x7ff
s_sub_u32 s70, 2047, s70
s_nop 2
s_and_b32 s71, s73, 0x7ff
s_sub_u32 s71, 2047, s71
v_mov_b32 v8, 0
v_mov_b32 v72, s70
v_mov_b32 v73, s71
v_mov_b32 v74, s72
v_mov_b32 v75, s73
ds_write_b128 v8, v[72:75]
s_waitcnt lgkmcnt(0)
s_barrier
s_add_u32 s35, s34, 0
buffer_load_dwordx4 v[88:91], v7, s[8:11], s35 offen
s_add_u32 s35, s34, 3072
buffer_load_dwordx4 v[92:95], v7, s[8:11], s35 offen
s_add_u32 s35, s34, 6144
buffer_load_dwordx4 v[96:99], v7, s[8:11], s35 offen
s_add_u32 s35, s34, 9216
buffer_load_dwordx4 v[100:103], v7, s[8:11], s35 offen
s_add_u32 s35, s34, 12288
buffer_load_dwordx4 v[104:107], v7, s[8:11], s35 offen
s_add_u32 s35, s34, 15360
buffer_load_dwordx4 v[108:111], v7, s[8:11], s35 offen
s_add_u32 s35, s34, 18432
buffer_load_dwordx4 v[112:115], v7, s[8:11], s35 offen
s_add_u32 s35, s34, 21504
buffer_load_dwordx4 v[116:119], v7, s[8:11], s35 offen
s_add_u32 s35, s34, 98304
buffer_load_dwordx4 v[120:123], v7, s[8:11], s35 offen
s_add_u32 s35, s34, 101376
buffer_load_dwordx4 v[124:127], v7, s[8:11], s35 offen
s_add_u32 s35, s34, 104448
buffer_load_dwordx4 v[128:131], v7, s[8:11], s35 offen
s_add_u32 s35, s34, 107520
buffer_load_dwordx4 v[132:135], v7, s[8:11], s35 offen
s_add_u32 s35, s34, 110592
buffer_load_dwordx4 v[136:139], v7, s[8:11], s35 offen
s_add_u32 s35, s34, 113664
buffer_load_dwordx4 v[140:143], v7, s[8:11], s35 offen
s_add_u32 s35, s34, 116736
buffer_load_dwordx4 v[144:147], v7, s[8:11], s35 offen
s_add_u32 s35, s34, 119808
buffer_load_dwordx4 v[148:151], v7, s[8:11], s35 offen
s_add_u32 s35, s34, 196608
buffer_load_dwordx4 v[152:155], v7, s[8:11], s35 offen
s_add_u32 s35, s34, 199680
buffer_load_dwordx4 v[156:159], v7, s[8:11], s35 offen
s_add_u32 s35, s34, 202752
buffer_load_dwordx4 v[160:163], v7, s[8:11], s35 offen
s_add_u32 s35, s34, 205824
buffer_load_dwordx4 v[164:167], v7, s[8:11], s35 offen
s_add_u32 s35, s34, 208896
buffer_load_dwordx4 v[168:171], v7, s[8:11], s35 offen
s_add_u32 s35, s34, 211968
buffer_load_dwordx4 v[172:175], v7, s[8:11], s35 offen
s_add_u32 s35, s34, 215040
buffer_load_dwordx4 v[176:179], v7, s[8:11], s35 offen
s_add_u32 s35, s34, 218112
buffer_load_dwordx4 v[180:183], v7, s[8:11], s35 offen
L_ax_j:
s_mov_b32 s52, s70
s_mov_b32 s53, s71

v_and_b32 v8, 1, v2
v_cmp_eq_u32 vcc, 1, v8
v_mov_b32 v9, s52
v_mov_b32 v10, s53
v_cndmask_b32 v9, v9, v10, vcc
v_lshlrev_b32 v10, 4, v9
s_mov_b32 s50, 11534336
buffer_load_dwordx2 v[12:13], v10, s[20:23], s50 offen sc1
v_mul_u32_u24 v9, 1280, v9
v_lshlrev_b32 v10, 4, v3
v_add_u32 v9, v9, v10
s_and_b32 s33, s30, 3
s_mul_i32 s36, s33, 320

s_add_u32 s35, s36, 0
buffer_load_dwordx4 v[16:19], v9, s[4:7], s35 offen
s_add_u32 s35, s36, 64
buffer_load_dwordx4 v[20:23], v9, s[4:7], s35 offen
s_add_u32 s35, s36, 128
buffer_load_dwordx4 v[24:27], v9, s[4:7], s35 offen
s_add_u32 s35, s36, 192
buffer_load_dwordx4 v[28:31], v9, s[4:7], s35 offen
s_add_u32 s35, s36, 256
buffer_load_dwordx4 v[32:35], v9, s[4:7], s35 offen
s_add_u32 s35, s34, 294912
buffer_load_dwordx4 v[184:187], v7, s[8:11], s35 offen
s_add_u32 s35, s34, 297984
buffer_load_dwordx4 v[188:191], v7, s[8:11], s35 offen
s_add_u32 s35, s34, 301056
buffer_load_dwordx4 v[192:195], v7, s[8:11], s35 offen
s_add_u32 s35, s34, 304128
buffer_load_dwordx4 v[196:199], v7, s[8:11], s35 offen
s_add_u32 s35, s34, 307200
buffer_load_dwordx4 v[200:203], v7, s[8:11], s35 offen
s_add_u32 s35, s34, 310272
buffer_load_dwordx4 v[204:207], v7, s[8:11], s35 offen
s_add_u32 s35, s34, 313344
buffer_load_dwordx4 v[208:211], v7, s[8:11], s35 offen
s_add_u32 s35, s34, 316416
buffer_load_dwordx4 v[212:215], v7, s[8:11], s35 offen
s_add_u32 s35, s34, 393216
buffer_load_dwordx4 v[216:219], v7, s[8:11], s35 offen
s_add_u32 s35, s34, 396288
buffer_load_dwordx4 v[220:223], v7, s[8:11], s35 offen
s_add_u32 s35, s34, 399360
buffer_load_dwordx4 v[224:227], v7, s[8:11], s35 offen
s_add_u32 s35, s34, 402432
buffer_load_dwordx4 v[228:231], v7, s[8:11], s35 offen
s_add_u32 s35, s34, 405504
buffer_load_dwordx4 v[232:235], v7, s[8:11], s35 offen
s_add_u32 s35, s34, 408576
buffer_load_dwordx4 v[236:239], v7, s[8:11], s35 offen
s_add_u32 s35, s34, 411648
buffer_load_dwordx4 v[240:243], v7, s[8:11], s35 offen
s_add_u32 s35, s34, 414720
buffer_load_dwordx4 v[244:247], v7, s[8:11], s35 offen
s_waitcnt vmcnt(16)
v_lshlrev_b32 v36, 16, v16
v_and_b32 v37, 0xffff0000, v16
v_pk_add_f32 v[36:37], v[36:37], v[12:13] op_sel_hi:[1,0] neg_lo:[0,1] neg_hi:[0,1]
v_cvt_pk_bf16_f32 v36, v36, v37
v_and_b32 v37, 0xffff0000, v36
v_lshlrev_b32 v36, 16, v36
v_pk_mul_f32 v[36:37], v[36:37], v[12:13] op_sel:[0,1] op_sel_hi:[1,1]
v_cvt_pk_bf16_f32 v16, v36, v37
v_lshlrev_b32 v36, 16, v17
v_and_b32 v37, 0xffff0000, v17
v_pk_add_f32 v[36:37], v[36:37], v[12:13] op_sel_hi:[1,0] neg_lo:[0,1] neg_hi:[0,1]
v_cvt_pk_bf16_f32 v36, v36, v37
v_and_b32 v37, 0xffff0000, v36
v_lshlrev_b32 v36, 16, v36
v_pk_mul_f32 v[36:37], v[36:37], v[12:13] op_sel:[0,1] op_sel_hi:[1,1]
v_cvt_pk_bf16_f32 v17, v36, v37
v_lshlrev_b32 v36, 16, v18
v_and_b32 v37, 0xffff0000, v18
v_pk_add_f32 v[36:37], v[36:37], v[12:13] op_sel_hi:[1,0] neg_lo:[0,1] neg_hi:[0,1]
v_cvt_pk_bf16_f32 v36, v36, v37
v_and_b32 v37, 0xffff0000, v36
v_lshlrev_b32 v36, 16, v36
v_pk_mul_f32 v[36:37], v[36:37], v[12:13] op_sel:[0,1] op_sel_hi:[1,1]
v_cvt_pk_bf16_f32 v18, v36, v37
v_lshlrev_b32 v36, 16, v19
v_and_b32 v37, 0xffff0000, v19
v_pk_add_f32 v[36:37], v[36:37], v[12:13] op_sel_hi:[1,0] neg_lo:[0,1] neg_hi:[0,1]
v_cvt_pk_bf16_f32 v36, v36, v37
v_and_b32 v37, 0xffff0000, v36
v_lshlrev_b32 v36, 16, v36
v_pk_mul_f32 v[36:37], v[36:37], v[12:13] op_sel:[0,1] op_sel_hi:[1,1]
v_cvt_pk_bf16_f32 v19, v36, v37
v_lshlrev_b32 v36, 16, v20
v_and_b32 v37, 0xffff0000, v20
v_pk_add_f32 v[36:37], v[36:37], v[12:13] op_sel_hi:[1,0] neg_lo:[0,1] neg_hi:[0,1]
v_cvt_pk_bf16_f32 v36, v36, v37
v_and_b32 v37, 0xffff0000, v36
v_lshlrev_b32 v36, 16, v36
v_pk_mul_f32 v[36:37], v[36:37], v[12:13] op_sel:[0,1] op_sel_hi:[1,1]
v_cvt_pk_bf16_f32 v20, v36, v37
v_lshlrev_b32 v36, 16, v21
v_and_b32 v37, 0xffff0000, v21
v_pk_add_f32 v[36:37], v[36:37], v[12:13] op_sel_hi:[1,0] neg_lo:[0,1] neg_hi:[0,1]
v_cvt_pk_bf16_f32 v36, v36, v37
v_and_b32 v37, 0xffff0000, v36
v_lshlrev_b32 v36, 16, v36
v_pk_mul_f32 v[36:37], v[36:37], v[12:13] op_sel:[0,1] op_sel_hi:[1,1]
v_cvt_pk_bf16_f32 v21, v36, v37
v_lshlrev_b32 v36, 16, v22
v_and_b32 v37, 0xffff0000, v22
v_pk_add_f32 v[36:37], v[36:37], v[12:13] op_sel_hi:[1,0] neg_lo:[0,1] neg_hi:[0,1]
v_cvt_pk_bf16_f32 v36, v36, v37
v_and_b32 v37, 0xffff0000, v36
v_lshlrev_b32 v36, 16, v36
v_pk_mul_f32 v[36:37], v[36:37], v[12:13] op_sel:[0,1] op_sel_hi:[1,1]
v_cvt_pk_bf16_f32 v22, v36, v37
v_lshlrev_b32 v36, 16, v23
v_and_b32 v37, 0xffff0000, v23
v_pk_add_f32 v[36:37], v[36:37], v[12:13] op_sel_hi:[1,0] neg_lo:[0,1] neg_hi:[0,1]
v_cvt_pk_bf16_f32 v36, v36, v37
v_and_b32 v37, 0xffff0000, v36
v_lshlrev_b32 v36, 16, v36
v_pk_mul_f32 v[36:37], v[36:37], v[12:13] op_sel:[0,1] op_sel_hi:[1,1]
v_cvt_pk_bf16_f32 v23, v36, v37
v_lshlrev_b32 v36, 16, v24
v_and_b32 v37, 0xffff0000, v24
v_pk_add_f32 v[36:37], v[36:37], v[12:13] op_sel_hi:[1,0] neg_lo:[0,1] neg_hi:[0,1]
v_cvt_pk_bf16_f32 v36, v36, v37
v_and_b32 v37, 0xffff0000, v36
v_lshlrev_b32 v36, 16, v36
v_pk_mul_f32 v[36:37], v[36:37], v[12:13] op_sel:[0,1] op_sel_hi:[1,1]
v_cvt_pk_bf16_f32 v24, v36, v37
v_lshlrev_b32 v36, 16, v25
v_and_b32 v37, 0xffff0000, v25
v_pk_add_f32 v[36:37], v[36:37], v[12:13] op_sel_hi:[1,0] neg_lo:[0,1] neg_hi:[0,1]
v_cvt_pk_bf16_f32 v36, v36, v37
v_and_b32 v37, 0xffff0000, v36
v_lshlrev_b32 v36, 16, v36
v_pk_mul_f32 v[36:37], v[36:37], v[12:13] op_sel:[0,1] op_sel_hi:[1,1]
v_cvt_pk_bf16_f32 v25, v36, v37
v_lshlrev_b32 v36, 16, v26
v_and_b32 v37, 0xffff0000, v26
v_pk_add_f32 v[36:37], v[36:37], v[12:13] op_sel_hi:[1,0] neg_lo:[0,1] neg_hi:[0,1]
v_cvt_pk_bf16_f32 v36, v36, v37
v_and_b32 v37, 0xffff0000, v36
v_lshlrev_b32 v36, 16, v36
v_pk_mul_f32 v[36:37], v[36:37], v[12:13] op_sel:[0,1] op_sel_hi:[1,1]
v_cvt_pk_bf16_f32 v26, v36, v37
v_lshlrev_b32 v36, 16, v27
v_and_b32 v37, 0xffff0000, v27
v_pk_add_f32 v[36:37], v[36:37], v[12:13] op_sel_hi:[1,0] neg_lo:[0,1] neg_hi:[0,1]
v_cvt_pk_bf16_f32 v36, v36, v37
v_and_b32 v37, 0xffff0000, v36
v_lshlrev_b32 v36, 16, v36
v_pk_mul_f32 v[36:37], v[36:37], v[12:13] op_sel:[0,1] op_sel_hi:[1,1]
v_cvt_pk_bf16_f32 v27, v36, v37
v_lshlrev_b32 v36, 16, v28
v_and_b32 v37, 0xffff0000, v28
v_pk_add_f32 v[36:37], v[36:37], v[12:13] op_sel_hi:[1,0] neg_lo:[0,1] neg_hi:[0,1]
v_cvt_pk_bf16_f32 v36, v36, v37
v_and_b32 v37, 0xffff0000, v36
v_lshlrev_b32 v36, 16, v36
v_pk_mul_f32 v[36:37], v[36:37], v[12:13] op_sel:[0,1] op_sel_hi:[1,1]
v_cvt_pk_bf16_f32 v28, v36, v37
v_lshlrev_b32 v36, 16, v29
v_and_b32 v37, 0xffff0000, v29
v_pk_add_f32 v[36:37], v[36:37], v[12:13] op_sel_hi:[1,0] neg_lo:[0,1] neg_hi:[0,1]
v_cvt_pk_bf16_f32 v36, v36, v37
v_and_b32 v37, 0xffff0000, v36
v_lshlrev_b32 v36, 16, v36
v_pk_mul_f32 v[36:37], v[36:37], v[12:13] op_sel:[0,1] op_sel_hi:[1,1]
v_cvt_pk_bf16_f32 v29, v36, v37
v_lshlrev_b32 v36, 16, v30
v_and_b32 v37, 0xffff0000, v30
v_pk_add_f32 v[36:37], v[36:37], v[12:13] op_sel_hi:[1,0] neg_lo:[0,1] neg_hi:[0,1]
v_cvt_pk_bf16_f32 v36, v36, v37
v_and_b32 v37, 0xffff0000, v36
v_lshlrev_b32 v36, 16, v36
v_pk_mul_f32 v[36:37], v[36:37], v[12:13] op_sel:[0,1] op_sel_hi:[1,1]
v_cvt_pk_bf16_f32 v30, v36, v37
v_lshlrev_b32 v36, 16, v31
v_and_b32 v37, 0xffff0000, v31
v_pk_add_f32 v[36:37], v[36:37], v[12:13] op_sel_hi:[1,0] neg_lo:[0,1] neg_hi:[0,1]
v_cvt_pk_bf16_f32 v36, v36, v37
v_and_b32 v37, 0xffff0000, v36
v_lshlrev_b32 v36, 16, v36
v_pk_mul_f32 v[36:37], v[36:37], v[12:13] op_sel:[0,1] op_sel_hi:[1,1]
v_cvt_pk_bf16_f32 v31, v36, v37
v_lshlrev_b32 v36, 16, v32
v_and_b32 v37, 0xffff0000, v32
v_pk_add_f32 v[36:37], v[36:37], v[12:13] op_sel_hi:[1,0] neg_lo:[0,1] neg_hi:[0,1]
v_cvt_pk_bf16_f32 v36, v36, v37
v_and_b32 v37, 0xffff0000, v36
v_lshlrev_b32 v36, 16, v36
v_pk_mul_f32 v[36:37], v[36:37], v[12:13] op_sel:[0,1] op_sel_hi:[1,1]
v_cvt_pk_bf16_f32 v32, v36, v37
v_lshlrev_b32 v36, 16, v33
v_and_b32 v37, 0xffff0000, v33
v_pk_add_f32 v[36:37], v[36:37], v[12:13] op_sel_hi:[1,0] neg_lo:[0,1] neg_hi:[0,1]
v_cvt_pk_bf16_f32 v36, v36, v37
v_and_b32 v37, 0xffff0000, v36
v_lshlrev_b32 v36, 16, v36
v_pk_mul_f32 v[36:37], v[36:37], v[12:13] op_sel:[0,1] op_sel_hi:[1,1]
v_cvt_pk_bf16_f32 v33, v36, v37
v_lshlrev_b32 v36, 16, v34
v_and_b32 v37, 0xffff0000, v34
v_pk_add_f32 v[36:37], v[36:37], v[12:13] op_sel_hi:[1,0] neg_lo:[0,1] neg_hi:[0,1]
v_cvt_pk_bf16_f32 v36, v36, v37
v_and_b32 v37, 0xffff0000, v36
v_lshlrev_b32 v36, 16, v36
v_pk_mul_f32 v[36:37], v[36:37], v[12:13] op_sel:[0,1] op_sel_hi:[1,1]
v_cvt_pk_bf16_f32 v34, v36, v37
v_lshlrev_b32 v36, 16, v35
v_and_b32 v37, 0xffff0000, v35
v_pk_add_f32 v[36:37], v[36:37], v[12:13] op_sel_hi:[1,0] neg_lo:[0,1] neg_hi:[0,1]
v_cvt_pk_bf16_f32 v36, v36, v37
v_and_b32 v37, 0xffff0000, v36
v_lshlrev_b32 v36, 16, v36
v_pk_mul_f32 v[36:37], v[36:37], v[12:13] op_sel:[0,1] op_sel_hi:[1,1]
v_cvt_pk_bf16_f32 v35, v36, v37
s_mov_b32 s50, 0x05040100
s_mov_b32 s51, 0x07060302
v_perm_b32 v72, v92, v88, s50
v_perm_b32 v73, v100, v96, s50
v_perm_b32 v74, v108, v104, s50
v_perm_b32 v75, v116, v112, s50
s_nop 1
v_mfma_f32_16x16x32_bf16 v[40:43], v[72:75], v[16:19], 0
v_perm_b32 v76, v92, v88, s51
v_perm_b32 v77, v100, v96, s51
v_perm_b32 v78, v108, v104, s51
v_perm_b32 v79, v116, v112, s51
s_nop 1
v_mfma_f32_16x16x32_bf16 v[44:47], v[76:79], v[16:19], 0
v_perm_b32 v72, v93, v89, s50
v_perm_b32 v73, v101, v97, s50
v_perm_b32 v74, v109, v105, s50
v_perm_b32 v75, v117, v113, s50
s_nop 1
v_mfma_f32_16x16x32_bf16 v[48:51], v[72:75], v[16:19], 0
v_perm_b32 v76, v93, v89, s51
v_perm_b32 v77, v101, v97, s51
v_perm_b32 v78, v109, v105, s51
v_perm_b32 v79, v117, v113, s51
s_nop 1
v_mfma_f32_16x16x32_bf16 v[52:55], v[76:79], v[16:19], 0
v_perm_b32 v72, v94, v90, s50
v_perm_b32 v73, v102, v98, s50
v_perm_b32 v74, v110, v106, s50
v_perm_b32 v75, v118, v114, s50
s_nop 1
v_mfma_f32_16x16x32_bf16 v[56:59], v[72:75], v[16:19], 0
v_perm_b32 v76, v94, v90, s51
v_perm_b32 v77, v102, v98, s51
v_perm_b32 v78, v110, v106, s51
v_perm_b32 v79, v118, v114, s51
s_nop 1
v_mfma_f32_16x16x32_bf16 v[60:63], v[76:79], v[16:19], 0
v_perm_b32 v72, v95, v91, s50
v_perm_b32 v73, v103, v99, s50
v_perm_b32 v74, v111, v107, s50
v_perm_b32 v75, v119, v115, s50
s_nop 1
v_mfma_f32_16x16x32_bf16 v[64:67], v[72:75], v[16:19], 0
v_perm_b32 v76, v95, v91, s51
v_perm_b32 v77, v103, v99, s51
v_perm_b32 v78, v111, v107, s51
v_perm_b32 v79, v119, v115, s51
s_nop 1
v_mfma_f32_16x16x32_bf16 v[68:71], v[76:79], v[16:19], 0
v_perm_b32 v72, v124, v120, s50
v_perm_b32 v73, v132, v128, s50
v_perm_b32 v74, v140, v136, s50
v_perm_b32 v75, v148, v144, s50
s_nop 1
v_mfma_f32_16x16x32_bf16 v[40:43], v[72:75], v[20:23], v[40:43]
v_perm_b32 v76, v124, v120, s51
v_perm_b32 v77, v132, v128, s51
v_perm_b32 v78, v140, v136, s51
v_perm_b32 v79, v148, v144, s51
s_nop 1
v_mfma_f32_16x16x32_bf16 v[44:47], v[76:79], v[20:23], v[44:47]
v_perm_b32 v72, v125, v121, s50
v_perm_b32 v73, v133, v129, s50
v_perm_b32 v74, v141, v137, s50
v_perm_b32 v75, v149, v145, s50
s_nop 1
v_mfma_f32_16x16x32_bf16 v[48:51], v[72:75], v[20:23], v[48:51]
v_perm_b32 v76, v125, v121, s51
v_perm_b32 v77, v133, v129, s51
v_perm_b32 v78, v141, v137, s51
v_perm_b32 v79, v149, v145, s51
s_nop 1
v_mfma_f32_16x16x32_bf16 v[52:55], v[76:79], v[20:23], v[52:55]
v_perm_b32 v72, v126, v122, s50
v_perm_b32 v73, v134, v130, s50
v_perm_b32 v74, v142, v138, s50
v_perm_b32 v75, v150, v146, s50
s_nop 1
v_mfma_f32_16x16x32_bf16 v[56:59], v[72:75], v[20:23], v[56:59]
v_perm_b32 v76, v126, v122, s51
v_perm_b32 v77, v134, v130, s51
v_perm_b32 v78, v142, v138, s51
v_perm_b32 v79, v150, v146, s51
s_nop 1
v_mfma_f32_16x16x32_bf16 v[60:63], v[76:79], v[20:23], v[60:63]
v_perm_b32 v72, v127, v123, s50
v_perm_b32 v73, v135, v131, s50
v_perm_b32 v74, v143, v139, s50
v_perm_b32 v75, v151, v147, s50
s_nop 1
v_mfma_f32_16x16x32_bf16 v[64:67], v[72:75], v[20:23], v[64:67]
v_perm_b32 v76, v127, v123, s51
v_perm_b32 v77, v135, v131, s51
v_perm_b32 v78, v143, v139, s51
v_perm_b32 v79, v151, v147, s51
s_nop 1
v_mfma_f32_16x16x32_bf16 v[68:71], v[76:79], v[20:23], v[68:71]
s_mov_b32 s12, s78
s_mov_b32 s13, s79
s_mov_b32 s14, 1966080
s_mov_b32 s15, 0x20000
v_mul_u32_u24 v6, 10240, v3
v_lshlrev_b32 v8, 4, v4
v_add_u32 v6, v6, v8
s_mul_i32 s36, s31, 122880
s_add_u32 s37, s30, 0
s_mul_hi_u32 s38, s37, 858993460
s_mul_i32 s39, s38, 5
s_sub_u32 s39, s37, s39
s_mul_i32 s40, s38, 40960
s_lshl_b32 s41, s39, 8
s_add_u32 s40, s40, s41
s_add_u32 s40, s40, s36
s_mov_b32 s44, s38
s_mov_b32 s45, s39
s_add_u32 s42, s40, 0
buffer_load_dwordx4 v[88:91], v6, s[12:15], s42 offen
s_add_u32 s42, s40, 1280
buffer_load_dwordx4 v[92:95], v6, s[12:15], s42 offen
s_add_u32 s42, s40, 2560
buffer_load_dwordx4 v[96:99], v6, s[12:15], s42 offen
s_add_u32 s42, s40, 3840
buffer_load_dwordx4 v[100:103], v6, s[12:15], s42 offen
s_add_u32 s42, s40, 5120
buffer_load_dwordx4 v[104:107], v6, s[12:15], s42 offen
s_add_u32 s42, s40, 6400
buffer_load_dwordx4 v[108:111], v6, s[12:15], s42 offen
s_add_u32 s42, s40, 7680
buffer_load_dwordx4 v[112:115], v6, s[12:15], s42 offen
s_add_u32 s42, s40, 8960
buffer_load_dwordx4 v[116:119], v6, s[12:15], s42 offen
s_add_u32 s37, s30, 8
s_mul_hi_u32 s38, s37, 858993460
s_mul_i32 s39, s38, 5
s_sub_u32 s39, s37, s39
s_mul_i32 s40, s38, 40960
s_lshl_b32 s41, s39, 8
s_add_u32 s40, s40, s41
s_add_u32 s40, s40, s36
s_mov_b32 s46, s38
s_mov_b32 s47, s39
s_add_u32 s42, s40, 0
buffer_load_dwordx4 v[120:123], v6, s[12:15], s42 offen
s_add_u32 s42, s40, 1280
buffer_load_dwordx4 v[124:127], v6, s[12:15], s42 offen
s_add_u32 s42, s40, 2560
buffer_load_dwordx4 v[128:131], v6, s[12:15], s42 offen
s_add_u32 s42, s40, 3840
buffer_load_dwordx4 v[132:135], v6, s[12:15], s42 offen
s_add_u32 s42, s40, 5120
buffer_load_dwordx4 v[136:139], v6, s[12:15], s42 offen
s_add_u32 s42, s40, 6400
buffer_load_dwordx4 v[140:143], v6, s[12:15], s42 offen
s_add_u32 s42, s40, 7680
buffer_load_dwordx4 v[144:147], v6, s[12:15], s42 offen
s_add_u32 s42, s40, 8960
buffer_load_dwordx4 v[148:151], v6, s[12:15], s42 offen
v_perm_b32 v72, v156, v152, s50
v_perm_b32 v73, v164, v160, s50
v_perm_b32 v74, v172, v168, s50
v_perm_b32 v75, v180, v176, s50
s_nop 1
v_mfma_f32_16x16x32_bf16 v[40:43], v[72:75], v[24:27], v[40:43]
v_perm_b32 v76, v156, v152, s51
v_perm_b32 v77, v164, v160, s51
v_perm_b32 v78, v172, v168, s51
v_perm_b32 v79, v180, v176, s51
s_nop 1
v_mfma_f32_16x16x32_bf16 v[44:47], v[76:79], v[24:27], v[44:47]
v_perm_b32 v72, v157, v153, s50
v_perm_b32 v73, v165, v161, s50
v_perm_b32 v74, v173, v169, s50
v_perm_b32 v75, v181, v177, s50
s_nop 1
v_mfma_f32_16x16x32_bf16 v[48:51], v[72:75], v[24:27], v[48:51]
v_perm_b32 v76, v157, v153, s51
v_perm_b32 v77, v165, v161, s51
v_perm_b32 v78, v173, v169, s51
v_perm_b32 v79, v181, v177, s51
s_nop 1
v_mfma_f32_16x16x32_bf16 v[52:55], v[76:79], v[24:27], v[52:55]
v_perm_b32 v72, v158, v154, s50
v_perm_b32 v73, v166, v162, s50
v_perm_b32 v74, v174, v170, s50
v_perm_b32 v75, v182, v178, s50
s_nop 1
v_mfma_f32_16x16x32_bf16 v[56:59], v[72:75], v[24:27], v[56:59]
v_perm_b32 v76, v158, v154, s51
v_perm_b32 v77, v166, v162, s51
v_perm_b32 v78, v174, v170, s51
v_perm_b32 v79, v182, v178, s51
s_nop 1
v_mfma_f32_16x16x32_bf16 v[60:63], v[76:79], v[24:27], v[60:63]
v_perm_b32 v72, v159, v155, s50
v_perm_b32 v73, v167, v163, s50
v_perm_b32 v74, v175, v171, s50
v_perm_b32 v75, v183, v179, s50
s_nop 1
v_mfma_f32_16x16x32_bf16 v[64:67], v[72:75], v[24:27], v[64:67]
v_perm_b32 v76, v159, v155, s51
v_perm_b32 v77, v167, v163, s51
v_perm_b32 v78, v175, v171, s51
v_perm_b32 v79, v183, v179, s51
s_nop 1
v_mfma_f32_16x16x32_bf16 v[68:71], v[76:79], v[24:27], v[68:71]
s_waitcnt vmcnt(24)
v_perm_b32 v72, v188, v184, s50
v_perm_b32 v73, v196, v192, s50
v_perm_b32 v74, v204, v200, s50
v_perm_b32 v75, v212, v208, s50
s_nop 1
v_mfma_f32_16x16x32_bf16 v[40:43], v[72:75], v[28:31], v[40:43]
v_perm_b32 v76, v188, v184, s51
v_perm_b32 v77, v196, v192, s51
v_perm_b32 v78, v204, v200, s51
v_perm_b32 v79, v212, v208, s51
s_nop 1
v_mfma_f32_16x16x32_bf16 v[44:47], v[76:79], v[28:31], v[44:47]
v_perm_b32 v72, v189, v185, s50
v_perm_b32 v73, v197, v193, s50
v_perm_b32 v74, v205, v201, s50
v_perm_b32 v75, v213, v209, s50
s_nop 1
v_mfma_f32_16x16x32_bf16 v[48:51], v[72:75], v[28:31], v[48:51]
v_perm_b32 v76, v189, v185, s51
v_perm_b32 v77, v197, v193, s51
v_perm_b32 v78, v205, v201, s51
v_perm_b32 v79, v213, v209, s51
s_nop 1
v_mfma_f32_16x16x32_bf16 v[52:55], v[76:79], v[28:31], v[52:55]
v_perm_b32 v72, v190, v186, s50
v_perm_b32 v73, v198, v194, s50
v_perm_b32 v74, v206, v202, s50
v_perm_b32 v75, v214, v210, s50
s_nop 1
v_mfma_f32_16x16x32_bf16 v[56:59], v[72:75], v[28:31], v[56:59]
v_perm_b32 v76, v190, v186, s51
v_perm_b32 v77, v198, v194, s51
v_perm_b32 v78, v206, v202, s51
v_perm_b32 v79, v214, v210, s51
s_nop 1
v_mfma_f32_16x16x32_bf16 v[60:63], v[76:79], v[28:31], v[60:63]
v_perm_b32 v72, v191, v187, s50
v_perm_b32 v73, v199, v195, s50
v_perm_b32 v74, v207, v203, s50
v_perm_b32 v75, v215, v211, s50
s_nop 1
v_mfma_f32_16x16x32_bf16 v[64:67], v[72:75], v[28:31], v[64:67]
v_perm_b32 v76, v191, v187, s51
v_perm_b32 v77, v199, v195, s51
v_perm_b32 v78, v207, v203, s51
v_perm_b32 v79, v215, v211, s51
s_nop 1
v_mfma_f32_16x16x32_bf16 v[68:71], v[76:79], v[28:31], v[68:71]
s_waitcnt vmcnt(16)
v_perm_b32 v72, v220, v216, s50
v_perm_b32 v73, v228, v224, s50
v_perm_b32 v74, v236, v232, s50
v_perm_b32 v75, v244, v240, s50
s_nop 1
v_mfma_f32_16x16x32_bf16 v[40:43], v[72:75], v[32:35], v[40:43]
v_perm_b32 v76, v220, v216, s51
v_perm_b32 v77, v228, v224, s51
v_perm_b32 v78, v236, v232, s51
v_perm_b32 v79, v244, v240, s51
s_nop 1
v_mfma_f32_16x16x32_bf16 v[44:47], v[76:79], v[32:35], v[44:47]
v_perm_b32 v72, v221, v217, s50
v_perm_b32 v73, v229, v225, s50
v_perm_b32 v74, v237, v233, s50
v_perm_b32 v75, v245, v241, s50
s_nop 1
v_mfma_f32_16x16x32_bf16 v[48:51], v[72:75], v[32:35], v[48:51]
v_perm_b32 v76, v221, v217, s51
v_perm_b32 v77, v229, v225, s51
v_perm_b32 v78, v237, v233, s51
v_perm_b32 v79, v245, v241, s51
s_nop 1
v_mfma_f32_16x16x32_bf16 v[52:55], v[76:79], v[32:35], v[52:55]
v_perm_b32 v72, v222, v218, s50
v_perm_b32 v73, v230, v226, s50
v_perm_b32 v74, v238, v234, s50
v_perm_b32 v75, v246, v242, s50
s_nop 1
v_mfma_f32_16x16x32_bf16 v[56:59], v[72:75], v[32:35], v[56:59]
v_perm_b32 v76, v222, v218, s51
v_perm_b32 v77, v230, v226, s51
v_perm_b32 v78, v238, v234, s51
v_perm_b32 v79, v246, v242, s51
s_nop 1
v_mfma_f32_16x16x32_bf16 v[60:63], v[76:79], v[32:35], v[60:63]
v_perm_b32 v72, v223, v219, s50
v_perm_b32 v73, v231, v227, s50
v_perm_b32 v74, v239, v235, s50
v_perm_b32 v75, v247, v243, s50
s_nop 1
v_mfma_f32_16x16x32_bf16 v[64:67], v[72:75], v[32:35], v[64:67]
v_perm_b32 v76, v223, v219, s51
v_perm_b32 v77, v231, v227, s51
v_perm_b32 v78, v239, v235, s51
v_perm_b32 v79, v247, v243, s51
s_nop 1
v_mfma_f32_16x16x32_bf16 v[68:71], v[76:79], v[32:35], v[68:71]
s_lshl_b32 s98, s28, 2
s_lshr_b32 s99, s29, 3
s_add_u32 s98, s98, s99
s_and_b32 s99, s29, 7
s_mov_b32 s94, 429496730
v_add_u32 v206, 0, v0
v_mul_hi_u32 v207, v206, s94
v_mul_u32_u24 v208, 10, v207
v_sub_u32 v208, v206, v208
v_mul_u32_u24 v209, 336, v207
v_lshlrev_b32 v215, 5, v208
v_add_u32 v204, v209, v215
v_and_b32 v207, 63, v207
s_lshl_b32 s88, s98, 6
v_add_u32 v202, s88, v207
v_mul_u32_u24 v209, 1280, v202
v_lshlrev_b32 v215, 4, v208
v_add_u32 v209, v209, v215
s_mul_i32 s88, s99, 160
v_add_u32 v200, s88, v209
v_lshlrev_b32 v209, 4, v202
s_mov_b32 s88, 11534336
buffer_load_dwordx4 v[184:187], v200, s[4:7], 0 offen
buffer_load_dwordx4 v[192:195], v209, s[20:23], s88 offen sc1
v_add_u32 v206, 512, v0
v_mul_hi_u32 v207, v206, s94
v_mul_u32_u24 v208, 10, v207
v_sub_u32 v208, v206, v208
v_mul_u32_u24 v209, 336, v207
v_lshlrev_b32 v215, 5, v208
v_add_u32 v205, v209, v215
v_and_b32 v207, 63, v207
s_lshl_b32 s88, s98, 6
v_add_u32 v203, s88, v207
v_mul_u32_u24 v209, 1280, v203
v_lshlrev_b32 v215, 4, v208
v_add_u32 v209, v209, v215
s_mul_i32 s88, s99, 160
v_add_u32 v201, s88, v209
v_lshlrev_b32 v209, 4, v203
s_mov_b32 s88, 11534336
buffer_load_dwordx4 v[188:191], v201, s[4:7], 0 offen
buffer_load_dwordx4 v[196:199], v209, s[20:23], s88 offen sc1

v_and_b32 v8, 15, v2
v_mul_u32_u24 v9, 384, v8
v_lshlrev_b32 v10, 7, v3
v_add_u32 v9, v9, v10
s_mul_i32 s34, s30, 768
s_add_u32 s34, s34, 256
v_add_u32 v9, s34, v9
v_cmp_gt_u32 vcc, 2, v8
v_cmp_gt_u32 s[56:57], 3, v3
s_nop 3
s_and_b64 vcc, vcc, s[56:57]
s_and_saveexec_b64 s[60:61], vcc

ds_write_b32 v9, v40 offset:0
ds_write_b32 v9, v41 offset:32
ds_write_b32 v9, v42 offset:64
ds_write_b32 v9, v43 offset:96
ds_write_b32 v9, v44 offset:4
ds_write_b32 v9, v45 offset:36
ds_write_b32 v9, v46 offset:68
ds_write_b32 v9, v47 offset:100
ds_write_b32 v9, v48 offset:8
ds_write_b32 v9, v49 offset:40
ds_write_b32 v9, v50 offset:72
ds_write_b32 v9, v51 offset:104
ds_write_b32 v9, v52 offset:12
ds_write_b32 v9, v53 offset:44
ds_write_b32 v9, v54 offset:76
ds_write_b32 v9, v55 offset:108
ds_write_b32 v9, v56 offset:16
ds_write_b32 v9, v57 offset:48
ds_write_b32 v9, v58 offset:80
ds_write_b32 v9, v59 offset:112
ds_write_b32 v9, v60 offset:20
ds_write_b32 v9, v61 offset:52
ds_write_b32 v9, v62 offset:84
ds_write_b32 v9, v63 offset:116
ds_write_b32 v9, v64 offset:24
ds_write_b32 v9, v65 offset:56
ds_write_b32 v9, v66 offset:88
ds_write_b32 v9, v67 offset:120
ds_write_b32 v9, v68 offset:28
ds_write_b32 v9, v69 offset:60
ds_write_b32 v9, v70 offset:92
ds_write_b32 v9, v71 offset:124

s_mov_b64 exec, s[60:61]
s_waitcnt lgkmcnt(0)
s_barrier
v_mov_b32 v8, 192
v_cmp_gt_u32 vcc, v8, v0
v_lshlrev_b32 v9, 2, v0
v_add_u32 v9, 256, v9
s_nop 2
s_and_saveexec_b64 s[60:61], vcc
s_cbranch_execz L_moe_h_done

ds_read_b32 v16, v9 offset:0
ds_read_b32 v17, v9 offset:768
ds_read_b32 v18, v9 offset:1536
ds_read_b32 v19, v9 offset:2304
ds_read_b32 v20, v9 offset:3072
ds_read_b32 v21, v9 offset:3840
ds_read_b32 v22, v9 offset:4608
ds_read_b32 v23, v9 offset:5376
s_waitcnt lgkmcnt(0)
v_add_f32 v16, v16, v17
v_add_f32 v18, v18, v19
v_add_f32 v20, v20, v21
v_add_f32 v22, v22, v23
v_add_f32 v16, v16, v18
v_add_f32 v20, v20, v22
v_cvt_pk_bf16_f32 v16, v16, v20
v_and_b32 v20, 0xffff0000, v16
v_lshlrev_b32 v16, 16, v16
v_mul_f32 v17, 0xbfb8aa3b, v16
v_exp_f32 v17, v17
s_nop 0
v_add_f32 v17, 1.0, v17
v_rcp_f32 v17, v17
s_nop 0
v_mul_f32 v16, v16, v17
v_cvt_pk_bf16_f32 v16, v16, v16
v_lshlrev_b32 v16, 16, v16
v_mul_f32 v16, v16, v20
v_cvt_pk_bf16_f32 v16, v16, v16
v_lshlrev_b32 v9, 1, v0
v_add_u32 v9, 6400, v9
ds_write_b16 v9, v16
L_moe_h_done:
s_mov_b64 exec, s[60:61]
s_waitcnt lgkmcnt(0)
s_barrier
v_and_b32 v8, 1, v2
v_mul_u32_u24 v9, 192, v8
v_lshlrev_b32 v10, 4, v3
v_add_u32 v9, v9, v10
v_add_u32 v9, 6400, v9
s_waitcnt vmcnt(0)

s_lshl_b32 s34, s44, 6
v_add_u32 v10, s34, v9
ds_read_b128 v[16:19], v10
s_waitcnt lgkmcnt(0)
v_perm_b32 v72, v92, v88, s50
v_perm_b32 v73, v100, v96, s50
v_perm_b32 v74, v108, v104, s50
v_perm_b32 v75, v116, v112, s50
s_nop 1
v_mfma_f32_16x16x32_bf16 v[152:155], v[72:75], v[16:19], 0
v_perm_b32 v76, v92, v88, s51
v_perm_b32 v77, v100, v96, s51
v_perm_b32 v78, v108, v104, s51
v_perm_b32 v79, v116, v112, s51
s_nop 1
v_mfma_f32_16x16x32_bf16 v[156:159], v[76:79], v[16:19], 0
v_perm_b32 v72, v93, v89, s50
v_perm_b32 v73, v101, v97, s50
v_perm_b32 v74, v109, v105, s50
v_perm_b32 v75, v117, v113, s50
s_nop 1
v_mfma_f32_16x16x32_bf16 v[160:163], v[72:75], v[16:19], 0
v_perm_b32 v76, v93, v89, s51
v_perm_b32 v77, v101, v97, s51
v_perm_b32 v78, v109, v105, s51
v_perm_b32 v79, v117, v113, s51
s_nop 1
v_mfma_f32_16x16x32_bf16 v[164:167], v[76:79], v[16:19], 0
v_perm_b32 v72, v94, v90, s50
v_perm_b32 v73, v102, v98, s50
v_perm_b32 v74, v110, v106, s50
v_perm_b32 v75, v118, v114, s50
s_nop 1
v_mfma_f32_16x16x32_bf16 v[168:171], v[72:75], v[16:19], 0
v_perm_b32 v76, v94, v90, s51
v_perm_b32 v77, v102, v98, s51
v_perm_b32 v78, v110, v106, s51
v_perm_b32 v79, v118, v114, s51
s_nop 1
v_mfma_f32_16x16x32_bf16 v[172:175], v[76:79], v[16:19], 0
v_perm_b32 v72, v95, v91, s50
v_perm_b32 v73, v103, v99, s50
v_perm_b32 v74, v111, v107, s50
v_perm_b32 v75, v119, v115, s50
s_nop 1
v_mfma_f32_16x16x32_bf16 v[176:179], v[72:75], v[16:19], 0
v_perm_b32 v76, v95, v91, s51
v_perm_b32 v77, v103, v99, s51
v_perm_b32 v78, v111, v107, s51
v_perm_b32 v79, v119, v115, s51
s_nop 1
v_mfma_f32_16x16x32_bf16 v[180:183], v[76:79], v[16:19], 0
v_and_b32 v8, 15, v2
v_mul_u32_u24 v10, 2560, v8
v_lshlrev_b32 v11, 7, v3
v_add_u32 v10, v10, v11
s_mul_i32 s34, s44, 5120
s_lshl_b32 s35, s45, 9
s_add_u32 s34, s34, s35
s_add_u32 s34, s34, 6912
v_add_u32 v10, s34, v10
v_cmp_gt_u32 vcc, 2, v8
s_nop 4
s_and_saveexec_b64 s[60:61], vcc
ds_write_b32 v10, v152 offset:0
ds_write_b32 v10, v153 offset:32
ds_write_b32 v10, v154 offset:64
ds_write_b32 v10, v155 offset:96
ds_write_b32 v10, v156 offset:4
ds_write_b32 v10, v157 offset:36
ds_write_b32 v10, v158 offset:68
ds_write_b32 v10, v159 offset:100
ds_write_b32 v10, v160 offset:8
ds_write_b32 v10, v161 offset:40
ds_write_b32 v10, v162 offset:72
ds_write_b32 v10, v163 offset:104
ds_write_b32 v10, v164 offset:12
ds_write_b32 v10, v165 offset:44
ds_write_b32 v10, v166 offset:76
ds_write_b32 v10, v167 offset:108
ds_write_b32 v10, v168 offset:16
ds_write_b32 v10, v169 offset:48
ds_write_b32 v10, v170 offset:80
ds_write_b32 v10, v171 offset:112
ds_write_b32 v10, v172 offset:20
ds_write_b32 v10, v173 offset:52
ds_write_b32 v10, v174 offset:84
ds_write_b32 v10, v175 offset:116
ds_write_b32 v10, v176 offset:24
ds_write_b32 v10, v177 offset:56
ds_write_b32 v10, v178 offset:88
ds_write_b32 v10, v179 offset:120
ds_write_b32 v10, v180 offset:28
ds_write_b32 v10, v181 offset:60
ds_write_b32 v10, v182 offset:92
ds_write_b32 v10, v183 offset:124
s_mov_b64 exec, s[60:61]
s_cmp_eq_u32 s30, 7
s_cbranch_scc1 L_moe_dn_done
s_lshl_b32 s34, s46, 6
v_add_u32 v10, s34, v9
ds_read_b128 v[16:19], v10
s_waitcnt lgkmcnt(0)
v_perm_b32 v72, v124, v120, s50
v_perm_b32 v73, v132, v128, s50
v_perm_b32 v74, v140, v136, s50
v_perm_b32 v75, v148, v144, s50
s_nop 1
v_mfma_f32_16x16x32_bf16 v[152:155], v[72:75], v[16:19], 0
v_perm_b32 v76, v124, v120, s51
v_perm_b32 v77, v132, v128, s51
v_perm_b32 v78, v140, v136, s51
v_perm_b32 v79, v148, v144, s51
s_nop 1
v_mfma_f32_16x16x32_bf16 v[156:159], v[76:79], v[16:19], 0
v_perm_b32 v72, v125, v121, s50
v_perm_b32 v73, v133, v129, s50
v_perm_b32 v74, v141, v137, s50
v_perm_b32 v75, v149, v145, s50
s_nop 1
v_mfma_f32_16x16x32_bf16 v[160:163], v[72:75], v[16:19], 0
v_perm_b32 v76, v125, v121, s51
v_perm_b32 v77, v133, v129, s51
v_perm_b32 v78, v141, v137, s51
v_perm_b32 v79, v149, v145, s51
s_nop 1
v_mfma_f32_16x16x32_bf16 v[164:167], v[76:79], v[16:19], 0
v_perm_b32 v72, v126, v122, s50
v_perm_b32 v73, v134, v130, s50
v_perm_b32 v74, v142, v138, s50
v_perm_b32 v75, v150, v146, s50
s_nop 1
v_mfma_f32_16x16x32_bf16 v[168:171], v[72:75], v[16:19], 0
v_perm_b32 v76, v126, v122, s51
v_perm_b32 v77, v134, v130, s51
v_perm_b32 v78, v142, v138, s51
v_perm_b32 v79, v150, v146, s51
s_nop 1
v_mfma_f32_16x16x32_bf16 v[172:175], v[76:79], v[16:19], 0
v_perm_b32 v72, v127, v123, s50
v_perm_b32 v73, v135, v131, s50
v_perm_b32 v74, v143, v139, s50
v_perm_b32 v75, v151, v147, s50
s_nop 1
v_mfma_f32_16x16x32_bf16 v[176:179], v[72:75], v[16:19], 0
v_perm_b32 v76, v127, v123, s51
v_perm_b32 v77, v135, v131, s51
v_perm_b32 v78, v143, v139, s51
v_perm_b32 v79, v151, v147, s51
s_nop 1
v_mfma_f32_16x16x32_bf16 v[180:183], v[76:79], v[16:19], 0
v_and_b32 v8, 15, v2
v_mul_u32_u24 v10, 2560, v8
v_lshlrev_b32 v11, 7, v3
v_add_u32 v10, v10, v11
s_mul_i32 s34, s46, 5120
s_lshl_b32 s35, s47, 9
s_add_u32 s34, s34, s35
s_add_u32 s34, s34, 6912
v_add_u32 v10, s34, v10
v_cmp_gt_u32 vcc, 2, v8
s_nop 4
s_and_saveexec_b64 s[60:61], vcc
ds_write_b32 v10, v152 offset:0
ds_write_b32 v10, v153 offset:32
ds_write_b32 v10, v154 offset:64
ds_write_b32 v10, v155 offset:96
ds_write_b32 v10, v156 offset:4
ds_write_b32 v10, v157 offset:36
ds_write_b32 v10, v158 offset:68
ds_write_b32 v10, v159 offset:100
ds_write_b32 v10, v160 offset:8
ds_write_b32 v10, v161 offset:40
ds_write_b32 v10, v162 offset:72
ds_write_b32 v10, v163 offset:104
ds_write_b32 v10, v164 offset:12
ds_write_b32 v10, v165 offset:44
ds_write_b32 v10, v166 offset:76
ds_write_b32 v10, v167 offset:108
ds_write_b32 v10, v168 offset:16
ds_write_b32 v10, v169 offset:48
ds_write_b32 v10, v170 offset:80
ds_write_b32 v10, v171 offset:112
ds_write_b32 v10, v172 offset:20
ds_write_b32 v10, v173 offset:52
ds_write_b32 v10, v174 offset:84
ds_write_b32 v10, v175 offset:116
ds_write_b32 v10, v176 offset:24
ds_write_b32 v10, v177 offset:56
ds_write_b32 v10, v178 offset:88
ds_write_b32 v10, v179 offset:120
ds_write_b32 v10, v180 offset:28
ds_write_b32 v10, v181 offset:60
ds_write_b32 v10, v182 offset:92
ds_write_b32 v10, v183 offset:124
s_mov_b64 exec, s[60:61]
L_moe_dn_done:
s_waitcnt lgkmcnt(0)
s_barrier
v_mov_b32 v8, 320
v_cmp_gt_u32 vcc, v8, v0
v_lshlrev_b32 v9, 4, v0
v_add_u32 v10, 6912, v9
s_nop 2
s_and_saveexec_b64 s[60:61], vcc
s_cbranch_execz L_moe_y_done
ds_read_b128 v[16:19], v10
ds_read_b128 v[20:23], v10 offset:5120
ds_read_b128 v[24:27], v10 offset:10240
s_waitcnt lgkmcnt(0)
v_pk_add_f32 v[16:17], v[16:17], v[20:21]
v_pk_add_f32 v[18:19], v[18:19], v[22:23]
v_pk_add_f32 v[16:17], v[16:17], v[24:25]
v_pk_add_f32 v[18:19], v[18:19], v[26:27]
s_mul_i32 s34, s31, 5120
s_add_u32 s34, s34, 11665408
buffer_store_dwordx4 v[16:19], v9, s[20:23], s34 offen sc1
L_moe_y_done:
s_mov_b64 exec, s[60:61]
s_waitcnt vmcnt(0)
s_barrier
s_cmp_lg_u32 s30, 0
s_cbranch_scc1 L_moe_end
s_lshl_b32 s34, s31, 2
s_add_u32 s34, s34, 11866112

v_mov_b32 v16, s26
s_mov_b64 exec, 1
buffer_store_dword v16, off, s[20:23], s34 sc1
s_mov_b64 exec, -1
L_moe_end:
s_mov_b32 s8, s68
s_mov_b32 s9, s69
s_mov_b32 s10, 819200
s_mov_b32 s11, 0x20000
s_mov_b32 s94, 429496730
v_add_u32 v206, 0, v2
v_mul_hi_u32 v207, v206, s94
v_mul_u32_u24 v208, 10, v207
v_sub_u32 v208, v206, v208
v_mul_u32_u24 v207, 1280, v207
v_lshlrev_b32 v208, 4, v208
v_add_u32 v210, v207, v208
v_add_u32 v206, 64, v2
v_mul_hi_u32 v207, v206, s94
v_mul_u32_u24 v208, 10, v207
v_sub_u32 v208, v206, v208
v_mul_u32_u24 v207, 1280, v207
v_lshlrev_b32 v208, 4, v208
v_add_u32 v211, v207, v208
v_add_u32 v206, 128, v2
v_mul_hi_u32 v207, v206, s94
v_mul_u32_u24 v208, 10, v207
v_sub_u32 v208, v206, v208
v_mul_u32_u24 v207, 1280, v207
v_lshlrev_b32 v208, 4, v208
v_add_u32 v212, v207, v208
v_add_u32 v206, 192, v2
v_mul_hi_u32 v207, v206, s94
v_mul_u32_u24 v208, 10, v207
v_sub_u32 v208, v206, v208
v_mul_u32_u24 v207, 1280, v207
v_lshlrev_b32 v208, 4, v208
v_add_u32 v213, v207, v208
v_add_u32 v206, 256, v2
v_mul_hi_u32 v207, v206, s94
v_mul_u32_u24 v208, 10, v207
v_sub_u32 v208, v206, v208
v_mul_u32_u24 v207, 1280, v207
v_lshlrev_b32 v208, 4, v208
v_add_u32 v214, v207, v208
s_lshr_b32 s88, s30, 1
s_mul_i32 s89, s88, 204800
s_mul_i32 s90, s99, 160
s_add_u32 s89, s89, s90
s_mul_i32 s90, s88, 25728
s_add_u32 s90, s90, 49152
s_bitcmp1_b32 s30, 0
s_cbranch_scc1 L_wo_odd18
s_add_u32 m0, s90, 0
s_add_u32 s91, s89, 0
buffer_load_dwordx4 v210, s[8:11], s91 offen lds
s_add_u32 m0, s90, 1024
s_add_u32 s91, s89, 0
buffer_load_dwordx4 v211, s[8:11], s91 offen lds
s_add_u32 m0, s90, 2048
s_add_u32 s91, s89, 0
buffer_load_dwordx4 v212, s[8:11], s91 offen lds
s_add_u32 m0, s90, 3072
s_add_u32 s91, s89, 0
buffer_load_dwordx4 v213, s[8:11], s91 offen lds
s_add_u32 m0, s90, 4096
s_add_u32 s91, s89, 0
buffer_load_dwordx4 v214, s[8:11], s91 offen lds
s_add_u32 m0, s90, 5120
s_add_u32 s91, s89, 40960
buffer_load_dwordx4 v210, s[8:11], s91 offen lds
s_add_u32 m0, s90, 6144
s_add_u32 s91, s89, 40960
buffer_load_dwordx4 v211, s[8:11], s91 offen lds
s_add_u32 m0, s90, 7168
s_add_u32 s91, s89, 40960
buffer_load_dwordx4 v212, s[8:11], s91 offen lds
s_add_u32 m0, s90, 8192
s_add_u32 s91, s89, 40960
buffer_load_dwordx4 v213, s[8:11], s91 offen lds
s_add_u32 m0, s90, 9216
s_add_u32 s91, s89, 40960
buffer_load_dwordx4 v214, s[8:11], s91 offen lds
s_add_u32 m0, s90, 10240
s_add_u32 s91, s89, 81920
buffer_load_dwordx4 v210, s[8:11], s91 offen lds
s_add_u32 m0, s90, 11264
s_add_u32 s91, s89, 81920
buffer_load_dwordx4 v211, s[8:11], s91 offen lds
s_add_u32 m0, s90, 12288
s_add_u32 s91, s89, 81920
buffer_load_dwordx4 v212, s[8:11], s91 offen lds
s_branch L_wo_done18
L_wo_odd18:
s_add_u32 m0, s90, 13312
s_add_u32 s91, s89, 81920
buffer_load_dwordx4 v213, s[8:11], s91 offen lds
s_add_u32 m0, s90, 14336
s_add_u32 s91, s89, 81920
buffer_load_dwordx4 v214, s[8:11], s91 offen lds
s_add_u32 m0, s90, 15360
s_add_u32 s91, s89, 122880
buffer_load_dwordx4 v210, s[8:11], s91 offen lds
s_add_u32 m0, s90, 16384
s_add_u32 s91, s89, 122880
buffer_load_dwordx4 v211, s[8:11], s91 offen lds
s_add_u32 m0, s90, 17408
s_add_u32 s91, s89, 122880
buffer_load_dwordx4 v212, s[8:11], s91 offen lds
s_add_u32 m0, s90, 18432
s_add_u32 s91, s89, 122880
buffer_load_dwordx4 v213, s[8:11], s91 offen lds
s_add_u32 m0, s90, 19456
s_add_u32 s91, s89, 122880
buffer_load_dwordx4 v214, s[8:11], s91 offen lds
s_add_u32 m0, s90, 20480
s_add_u32 s91, s89, 163840
buffer_load_dwordx4 v210, s[8:11], s91 offen lds
s_add_u32 m0, s90, 21504
s_add_u32 s91, s89, 163840
buffer_load_dwordx4 v211, s[8:11], s91 offen lds
s_add_u32 m0, s90, 22528
s_add_u32 s91, s89, 163840
buffer_load_dwordx4 v212, s[8:11], s91 offen lds
s_add_u32 m0, s90, 23552
s_add_u32 s91, s89, 163840
buffer_load_dwordx4 v213, s[8:11], s91 offen lds
s_add_u32 m0, s90, 24576
s_add_u32 s91, s89, 163840
buffer_load_dwordx4 v214, s[8:11], s91 offen lds
L_wo_done18:
s_mov_b32 s27, 0x20000
s_branch L_xn_chk219
L_xn_chk19:
s_waitcnt vmcnt(0)
L_xn_chk219:
v_cmp_eq_u32 vcc, s26, v195
v_cmp_eq_u32 s[56:57], s26, v199
s_sub_u32 s27, s27, 1
s_nop 3
s_and_b64 vcc, vcc, s[56:57]
s_cmp_eq_u64 vcc, -1
s_cbranch_scc1 L_xn_ok19
s_cmp_eq_u32 s27, 0
s_cbranch_scc1 L_xn_ok19
v_lshlrev_b32 v209, 4, v202
s_mov_b32 s88, 11534336
buffer_load_dwordx4 v[192:195], v209, s[20:23], s88 offen sc1
v_lshlrev_b32 v209, 4, v203
s_mov_b32 s88, 11534336
buffer_load_dwordx4 v[196:199], v209, s[20:23], s88 offen sc1
s_branch L_xn_chk19
L_xn_ok19:
v_lshlrev_b32 v232, 16, v184
v_and_b32 v233, 0xffff0000, v184
v_pk_add_f32 v[216:217], v[232:233], v[192:193] op_sel_hi:[1,0] neg_lo:[0,1] neg_hi:[0,1]
v_cvt_pk_bf16_f32 v216, v216, v217
v_and_b32 v217, 0xffff0000, v216
v_lshlrev_b32 v216, 16, v216
v_pk_mul_f32 v[216:217], v[216:217], v[192:193] op_sel:[0,1] op_sel_hi:[1,1]
v_cvt_pk_bf16_f32 v216, v216, v217
v_and_b32 v217, 0xffff0000, v216
v_lshlrev_b32 v216, 16, v216
v_lshlrev_b32 v234, 16, v185
v_and_b32 v235, 0xffff0000, v185
v_pk_add_f32 v[218:219], v[234:235], v[192:193] op_sel_hi:[1,0] neg_lo:[0,1] neg_hi:[0,1]
v_cvt_pk_bf16_f32 v218, v218, v219
v_and_b32 v219, 0xffff0000, v218
v_lshlrev_b32 v218, 16, v218
v_pk_mul_f32 v[218:219], v[218:219], v[192:193] op_sel:[0,1] op_sel_hi:[1,1]
v_cvt_pk_bf16_f32 v218, v218, v219
v_and_b32 v219, 0xffff0000, v218
v_lshlrev_b32 v218, 16, v218
v_lshlrev_b32 v236, 16, v186
v_and_b32 v237, 0xffff0000, v186
v_pk_add_f32 v[220:221], v[236:237], v[192:193] op_sel_hi:[1,0] neg_lo:[0,1] neg_hi:[0,1]
v_cvt_pk_bf16_f32 v220, v220, v221
v_and_b32 v221, 0xffff0000, v220
v_lshlrev_b32 v220, 16, v220
v_pk_mul_f32 v[220:221], v[220:221], v[192:193] op_sel:[0,1] op_sel_hi:[1,1]
v_cvt_pk_bf16_f32 v220, v220, v221
v_and_b32 v221, 0xffff0000, v220
v_lshlrev_b32 v220, 16, v220
v_lshlrev_b32 v238, 16, v187
v_and_b32 v239, 0xffff0000, v187
v_pk_add_f32 v[222:223], v[238:239], v[192:193] op_sel_hi:[1,0] neg_lo:[0,1] neg_hi:[0,1]
v_cvt_pk_bf16_f32 v222, v222, v223
v_and_b32 v223, 0xffff0000, v222
v_lshlrev_b32 v222, 16, v222
v_pk_mul_f32 v[222:223], v[222:223], v[192:193] op_sel:[0,1] op_sel_hi:[1,1]
v_cvt_pk_bf16_f32 v222, v222, v223
v_and_b32 v223, 0xffff0000, v222
v_lshlrev_b32 v222, 16, v222
v_lshlrev_b32 v240, 16, v188
v_and_b32 v241, 0xffff0000, v188
v_pk_add_f32 v[224:225], v[240:241], v[196:197] op_sel_hi:[1,0] neg_lo:[0,1] neg_hi:[0,1]
v_cvt_pk_bf16_f32 v224, v224, v225
v_and_b32 v225, 0xffff0000, v224
v_lshlrev_b32 v224, 16, v224
v_pk_mul_f32 v[224:225], v[224:225], v[196:197] op_sel:[0,1] op_sel_hi:[1,1]
v_cvt_pk_bf16_f32 v224, v224, v225
v_and_b32 v225, 0xffff0000, v224
v_lshlrev_b32 v224, 16, v224
v_lshlrev_b32 v242, 16, v189
v_and_b32 v243, 0xffff0000, v189
v_pk_add_f32 v[226:227], v[242:243], v[196:197] op_sel_hi:[1,0] neg_lo:[0,1] neg_hi:[0,1]
v_cvt_pk_bf16_f32 v226, v226, v227
v_and_b32 v227, 0xffff0000, v226
v_lshlrev_b32 v226, 16, v226
v_pk_mul_f32 v[226:227], v[226:227], v[196:197] op_sel:[0,1] op_sel_hi:[1,1]
v_cvt_pk_bf16_f32 v226, v226, v227
v_and_b32 v227, 0xffff0000, v226
v_lshlrev_b32 v226, 16, v226
v_lshlrev_b32 v244, 16, v190
v_and_b32 v245, 0xffff0000, v190
v_pk_add_f32 v[228:229], v[244:245], v[196:197] op_sel_hi:[1,0] neg_lo:[0,1] neg_hi:[0,1]
v_cvt_pk_bf16_f32 v228, v228, v229
v_and_b32 v229, 0xffff0000, v228
v_lshlrev_b32 v228, 16, v228
v_pk_mul_f32 v[228:229], v[228:229], v[196:197] op_sel:[0,1] op_sel_hi:[1,1]
v_cvt_pk_bf16_f32 v228, v228, v229
v_and_b32 v229, 0xffff0000, v228
v_lshlrev_b32 v228, 16, v228
v_lshlrev_b32 v246, 16, v191
v_and_b32 v247, 0xffff0000, v191
v_pk_add_f32 v[230:231], v[246:247], v[196:197] op_sel_hi:[1,0] neg_lo:[0,1] neg_hi:[0,1]
v_cvt_pk_bf16_f32 v230, v230, v231
v_and_b32 v231, 0xffff0000, v230
v_lshlrev_b32 v230, 16, v230
v_pk_mul_f32 v[230:231], v[230:231], v[196:197] op_sel:[0,1] op_sel_hi:[1,1]
v_cvt_pk_bf16_f32 v230, v230, v231
v_and_b32 v231, 0xffff0000, v230
v_lshlrev_b32 v230, 16, v230
s_waitcnt vmcnt(0) lgkmcnt(0)
s_barrier
L_g2:
s_mov_b32 s12, s80
s_mov_b32 s13, s81
s_mov_b32 s14, 2621440
s_mov_b32 s15, 0x20000

s_lshr_b32 s36, s70, 6
s_lshr_b32 s37, s71, 6
s_cmp_eq_u32 s36, s98
s_cselect_b32 s38, 1, 0
s_cmp_eq_u32 s37, s98
s_cselect_b32 s39, 2, 0
s_or_b32 s38, s38, s39
v_lshrrev_b32 v4, 4, v2
v_and_b32 v3, 15, v2
s_lshl_b32 s36, s98, 6
s_and_b32 s37, s30, 3
s_lshl_b32 s37, s37, 4
s_add_u32 s36, s36, s37
v_add_u32 v3, s36, v3
v_lshlrev_b32 v3, 4, v3
v_lshlrev_b32 v5, 19, v4
v_add_u32 v82, v3, v5
v_lshlrev_b32 v5, 17, v4
v_add_u32 v81, v3, v5
s_lshl_b32 s36, s98, 8
s_add_u32 s95, s36, 11870208
v_lshlrev_b32 v16, 2, v2
v_bfe_u32 v5, v2, 2, 2
v_and_b32 v6, 3, v2
v_mul_u32_u24 v7, 25728, v4
v_mul_u32_u24 v5, 160, v5
v_add_u32 v7, v7, v5
v_lshlrev_b32 v6, 3, v6
v_add_u32 v7, v7, v6
s_lshr_b32 s37, s30, 2
s_mul_i32 s37, s37, 12800
s_add_u32 s37, s37, 49152
v_add_u32 v83, s37, v7
s_cmp_eq_u32 s38, 0
s_cbranch_scc1 L_g2_nomoe
s_and_b32 s54, s72, 0xffff0000
s_and_b32 s55, s73, 0xffff0000
s_xor_b32 s56, s54, 0x80000000
s_not_b32 s57, s54
s_and_b32 s57, s57, 0xffff0000
s_bitcmp1_b32 s54, 31
s_cselect_b32 s54, s56, s57
s_xor_b32 s56, s55, 0x80000000
s_not_b32 s57, s55
s_and_b32 s57, s57, 0xffff0000
s_bitcmp1_b32 s55, 31
s_cselect_b32 s55, s56, s57
v_mov_b32 v40, s54
v_mov_b32 v41, s55
v_mul_f32 v40, 0xbfb8aa3b, v40
v_mul_f32 v41, 0xbfb8aa3b, v41
v_exp_f32 v40, v40
v_exp_f32 v41, v41
s_nop 0
v_add_f32 v40, 1.0, v40
v_add_f32 v41, 1.0, v41
v_rcp_f32 v40, v40
v_rcp_f32 v41, v41
s_nop 0
v_cvt_pk_bf16_f32 v40, v40, v41
s_nop 0
v_readfirstlane_b32 s54, v40
s_nop 3
s_and_b32 s55, s54, 0xffff0000
s_lshl_b32 s54, s54, 16
s_mov_b32 s52, s70
s_mov_b32 s53, s71
s_mov_b32 s36, 11866112
s_mov_b32 s43, 0

v_cmp_eq_u32 vcc, s52, v202
s_nop 4
s_cmp_eq_u64 vcc, 0
s_cbranch_scc1 L_g2_mu20
s_mov_b64 s[40:41], vcc
s_cmp_lg_u32 s43, 0
s_cbranch_scc1 L_g2_mp20
s_mov_b32 s43, 1
s_mov_b32 s27, 0x20000
s_mov_b32 s56, 0xffff
s_mov_b32 s57, 0
L_pf21:
buffer_load_dword v17, v16, s[20:23], s36 offen sc1
s_waitcnt vmcnt(0)
v_cmp_eq_u32 vcc, s26, v17
s_sub_u32 s27, s27, 1
s_nop 3
s_andn2_b64 s[58:59], s[56:57], vcc
s_cmp_eq_u64 s[58:59], 0
s_cbranch_scc1 L_pfd21
s_sleep 2
s_cmp_lg_u32 s27, 0
s_cbranch_scc1 L_pf21
L_pfd21:
L_g2_mp20:
s_mov_b64 s[44:45], exec
s_mov_b64 exec, s[40:41]
v_mul_u32_u24 v17, 1280, v202
v_sub_u32 v17, v200, v17
v_lshlrev_b32 v17, 1, v17
s_mov_b32 s46, 11665408

buffer_load_dwordx4 v[84:87], v17, s[20:23], s46 offen sc1
buffer_load_dwordx4 v[88:91], v17, s[20:23], s46 offen offset:16 sc1
s_add_u32 s46, s46, 5120
buffer_load_dwordx4 v[92:95], v17, s[20:23], s46 offen sc1
buffer_load_dwordx4 v[96:99], v17, s[20:23], s46 offen offset:16 sc1
s_add_u32 s46, s46, 5120
buffer_load_dwordx4 v[100:103], v17, s[20:23], s46 offen sc1
buffer_load_dwordx4 v[104:107], v17, s[20:23], s46 offen offset:16 sc1
s_add_u32 s46, s46, 5120
buffer_load_dwordx4 v[108:111], v17, s[20:23], s46 offen sc1
buffer_load_dwordx4 v[112:115], v17, s[20:23], s46 offen offset:16 sc1
s_add_u32 s46, s46, 5120
buffer_load_dwordx4 v[116:119], v17, s[20:23], s46 offen sc1
buffer_load_dwordx4 v[120:123], v17, s[20:23], s46 offen offset:16 sc1
s_add_u32 s46, s46, 5120
buffer_load_dwordx4 v[124:127], v17, s[20:23], s46 offen sc1
buffer_load_dwordx4 v[128:131], v17, s[20:23], s46 offen offset:16 sc1
s_add_u32 s46, s46, 5120
buffer_load_dwordx4 v[132:135], v17, s[20:23], s46 offen sc1
buffer_load_dwordx4 v[136:139], v17, s[20:23], s46 offen offset:16 sc1
s_add_u32 s46, s46, 5120
buffer_load_dwordx4 v[140:143], v17, s[20:23], s46 offen sc1
buffer_load_dwordx4 v[144:147], v17, s[20:23], s46 offen offset:16 sc1
s_add_u32 s46, s46, 5120
buffer_load_dwordx4 v[148:151], v17, s[20:23], s46 offen sc1
buffer_load_dwordx4 v[152:155], v17, s[20:23], s46 offen offset:16 sc1
s_add_u32 s46, s46, 5120
buffer_load_dwordx4 v[156:159], v17, s[20:23], s46 offen sc1
buffer_load_dwordx4 v[160:163], v17, s[20:23], s46 offen offset:16 sc1
s_add_u32 s46, s46, 5120
buffer_load_dwordx4 v[164:167], v17, s[20:23], s46 offen sc1
buffer_load_dwordx4 v[168:171], v17, s[20:23], s46 offen offset:16 sc1
s_add_u32 s46, s46, 5120
buffer_load_dwordx4 v[20:23], v17, s[20:23], s46 offen sc1
buffer_load_dwordx4 v[24:27], v17, s[20:23], s46 offen offset:16 sc1
s_add_u32 s46, s46, 5120
buffer_load_dwordx4 v[28:31], v17, s[20:23], s46 offen sc1
buffer_load_dwordx4 v[32:35], v17, s[20:23], s46 offen offset:16 sc1
s_add_u32 s46, s46, 5120
buffer_load_dwordx4 v[36:39], v17, s[20:23], s46 offen sc1
buffer_load_dwordx4 v[40:43], v17, s[20:23], s46 offen offset:16 sc1
s_add_u32 s46, s46, 5120
buffer_load_dwordx4 v[44:47], v17, s[20:23], s46 offen sc1
buffer_load_dwordx4 v[48:51], v17, s[20:23], s46 offen offset:16 sc1
s_add_u32 s46, s46, 5120
buffer_load_dwordx4 v[52:55], v17, s[20:23], s46 offen sc1
buffer_load_dwordx4 v[56:59], v17, s[20:23], s46 offen offset:16 sc1
s_add_u32 s46, s46, 5120
s_waitcnt vmcnt(0)
v_pk_add_f32 v[84:85], v[84:85], v[92:93]
v_pk_add_f32 v[86:87], v[86:87], v[94:95]
v_pk_add_f32 v[88:89], v[88:89], v[96:97]
v_pk_add_f32 v[90:91], v[90:91], v[98:99]
v_pk_add_f32 v[84:85], v[84:85], v[100:101]
v_pk_add_f32 v[86:87], v[86:87], v[102:103]
v_pk_add_f32 v[88:89], v[88:89], v[104:105]
v_pk_add_f32 v[90:91], v[90:91], v[106:107]
v_pk_add_f32 v[84:85], v[84:85], v[108:109]
v_pk_add_f32 v[86:87], v[86:87], v[110:111]
v_pk_add_f32 v[88:89], v[88:89], v[112:113]
v_pk_add_f32 v[90:91], v[90:91], v[114:115]
v_pk_add_f32 v[84:85], v[84:85], v[116:117]
v_pk_add_f32 v[86:87], v[86:87], v[118:119]
v_pk_add_f32 v[88:89], v[88:89], v[120:121]
v_pk_add_f32 v[90:91], v[90:91], v[122:123]
v_pk_add_f32 v[84:85], v[84:85], v[124:125]
v_pk_add_f32 v[86:87], v[86:87], v[126:127]
v_pk_add_f32 v[88:89], v[88:89], v[128:129]
v_pk_add_f32 v[90:91], v[90:91], v[130:131]
v_pk_add_f32 v[84:85], v[84:85], v[132:133]
v_pk_add_f32 v[86:87], v[86:87], v[134:135]
v_pk_add_f32 v[88:89], v[88:89], v[136:137]
v_pk_add_f32 v[90:91], v[90:91], v[138:139]
v_pk_add_f32 v[84:85], v[84:85], v[140:141]
v_pk_add_f32 v[86:87], v[86:87], v[142:143]
v_pk_add_f32 v[88:89], v[88:89], v[144:145]
v_pk_add_f32 v[90:91], v[90:91], v[146:147]
v_pk_add_f32 v[84:85], v[84:85], v[148:149]
v_pk_add_f32 v[86:87], v[86:87], v[150:151]
v_pk_add_f32 v[88:89], v[88:89], v[152:153]
v_pk_add_f32 v[90:91], v[90:91], v[154:155]
v_pk_add_f32 v[84:85], v[84:85], v[156:157]
v_pk_add_f32 v[86:87], v[86:87], v[158:159]
v_pk_add_f32 v[88:89], v[88:89], v[160:161]
v_pk_add_f32 v[90:91], v[90:91], v[162:163]
v_pk_add_f32 v[84:85], v[84:85], v[164:165]
v_pk_add_f32 v[86:87], v[86:87], v[166:167]
v_pk_add_f32 v[88:89], v[88:89], v[168:169]
v_pk_add_f32 v[90:91], v[90:91], v[170:171]
v_pk_add_f32 v[84:85], v[84:85], v[20:21]
v_pk_add_f32 v[86:87], v[86:87], v[22:23]
v_pk_add_f32 v[88:89], v[88:89], v[24:25]
v_pk_add_f32 v[90:91], v[90:91], v[26:27]
v_pk_add_f32 v[84:85], v[84:85], v[28:29]
v_pk_add_f32 v[86:87], v[86:87], v[30:31]
v_pk_add_f32 v[88:89], v[88:89], v[32:33]
v_pk_add_f32 v[90:91], v[90:91], v[34:35]
v_pk_add_f32 v[84:85], v[84:85], v[36:37]
v_pk_add_f32 v[86:87], v[86:87], v[38:39]
v_pk_add_f32 v[88:89], v[88:89], v[40:41]
v_pk_add_f32 v[90:91], v[90:91], v[42:43]
v_pk_add_f32 v[84:85], v[84:85], v[44:45]
v_pk_add_f32 v[86:87], v[86:87], v[46:47]
v_pk_add_f32 v[88:89], v[88:89], v[48:49]
v_pk_add_f32 v[90:91], v[90:91], v[50:51]
v_pk_add_f32 v[84:85], v[84:85], v[52:53]
v_pk_add_f32 v[86:87], v[86:87], v[54:55]
v_pk_add_f32 v[88:89], v[88:89], v[56:57]
v_pk_add_f32 v[90:91], v[90:91], v[58:59]
v_mov_b32 v62, s54
v_cvt_pk_bf16_f32 v84, v84, v85
v_and_b32 v85, 0xffff0000, v84
v_lshlrev_b32 v84, 16, v84
v_pk_mul_f32 v[84:85], v[84:85], v[62:63] op_sel_hi:[1,0]
v_cvt_pk_bf16_f32 v84, v84, v85
v_and_b32 v85, 0xffff0000, v84
v_lshlrev_b32 v84, 16, v84
v_pk_add_f32 v[216:217], v[216:217], v[84:85]
v_cvt_pk_bf16_f32 v216, v216, v217
v_and_b32 v217, 0xffff0000, v216
v_lshlrev_b32 v216, 16, v216
v_cvt_pk_bf16_f32 v86, v86, v87
v_and_b32 v87, 0xffff0000, v86
v_lshlrev_b32 v86, 16, v86
v_pk_mul_f32 v[86:87], v[86:87], v[62:63] op_sel_hi:[1,0]
v_cvt_pk_bf16_f32 v86, v86, v87
v_and_b32 v87, 0xffff0000, v86
v_lshlrev_b32 v86, 16, v86
v_pk_add_f32 v[218:219], v[218:219], v[86:87]
v_cvt_pk_bf16_f32 v218, v218, v219
v_and_b32 v219, 0xffff0000, v218
v_lshlrev_b32 v218, 16, v218
v_cvt_pk_bf16_f32 v88, v88, v89
v_and_b32 v89, 0xffff0000, v88
v_lshlrev_b32 v88, 16, v88
v_pk_mul_f32 v[88:89], v[88:89], v[62:63] op_sel_hi:[1,0]
v_cvt_pk_bf16_f32 v88, v88, v89
v_and_b32 v89, 0xffff0000, v88
v_lshlrev_b32 v88, 16, v88
v_pk_add_f32 v[220:221], v[220:221], v[88:89]
v_cvt_pk_bf16_f32 v220, v220, v221
v_and_b32 v221, 0xffff0000, v220
v_lshlrev_b32 v220, 16, v220
v_cvt_pk_bf16_f32 v90, v90, v91
v_and_b32 v91, 0xffff0000, v90
v_lshlrev_b32 v90, 16, v90
v_pk_mul_f32 v[90:91], v[90:91], v[62:63] op_sel_hi:[1,0]
v_cvt_pk_bf16_f32 v90, v90, v91
v_and_b32 v91, 0xffff0000, v90
v_lshlrev_b32 v90, 16, v90
v_pk_add_f32 v[222:223], v[222:223], v[90:91]
v_cvt_pk_bf16_f32 v222, v222, v223
v_and_b32 v223, 0xffff0000, v222
v_lshlrev_b32 v222, 16, v222
s_mov_b64 exec, s[44:45]
L_g2_mu20:
v_cmp_eq_u32 vcc, s53, v202
s_nop 4
s_cmp_eq_u64 vcc, 0
s_cbranch_scc1 L_g2_mu22
s_mov_b64 s[40:41], vcc
s_cmp_lg_u32 s43, 0
s_cbranch_scc1 L_g2_mp22
s_mov_b32 s43, 1
s_mov_b32 s27, 0x20000
s_mov_b32 s56, 0xffff
s_mov_b32 s57, 0
L_pf23:
buffer_load_dword v17, v16, s[20:23], s36 offen sc1
s_waitcnt vmcnt(0)
v_cmp_eq_u32 vcc, s26, v17
s_sub_u32 s27, s27, 1
s_nop 3
s_andn2_b64 s[58:59], s[56:57], vcc
s_cmp_eq_u64 s[58:59], 0
s_cbranch_scc1 L_pfd23
s_sleep 2
s_cmp_lg_u32 s27, 0
s_cbranch_scc1 L_pf23
L_pfd23:
L_g2_mp22:
s_mov_b64 s[44:45], exec
s_mov_b64 exec, s[40:41]
v_mul_u32_u24 v17, 1280, v202
v_sub_u32 v17, v200, v17
v_lshlrev_b32 v17, 1, v17
s_mov_b32 s46, 11667968

buffer_load_dwordx4 v[84:87], v17, s[20:23], s46 offen sc1
buffer_load_dwordx4 v[88:91], v17, s[20:23], s46 offen offset:16 sc1
s_add_u32 s46, s46, 5120
buffer_load_dwordx4 v[92:95], v17, s[20:23], s46 offen sc1
buffer_load_dwordx4 v[96:99], v17, s[20:23], s46 offen offset:16 sc1
s_add_u32 s46, s46, 5120
buffer_load_dwordx4 v[100:103], v17, s[20:23], s46 offen sc1
buffer_load_dwordx4 v[104:107], v17, s[20:23], s46 offen offset:16 sc1
s_add_u32 s46, s46, 5120
buffer_load_dwordx4 v[108:111], v17, s[20:23], s46 offen sc1
buffer_load_dwordx4 v[112:115], v17, s[20:23], s46 offen offset:16 sc1
s_add_u32 s46, s46, 5120
buffer_load_dwordx4 v[116:119], v17, s[20:23], s46 offen sc1
buffer_load_dwordx4 v[120:123], v17, s[20:23], s46 offen offset:16 sc1
s_add_u32 s46, s46, 5120
buffer_load_dwordx4 v[124:127], v17, s[20:23], s46 offen sc1
buffer_load_dwordx4 v[128:131], v17, s[20:23], s46 offen offset:16 sc1
s_add_u32 s46, s46, 5120
buffer_load_dwordx4 v[132:135], v17, s[20:23], s46 offen sc1
buffer_load_dwordx4 v[136:139], v17, s[20:23], s46 offen offset:16 sc1
s_add_u32 s46, s46, 5120
buffer_load_dwordx4 v[140:143], v17, s[20:23], s46 offen sc1
buffer_load_dwordx4 v[144:147], v17, s[20:23], s46 offen offset:16 sc1
s_add_u32 s46, s46, 5120
buffer_load_dwordx4 v[148:151], v17, s[20:23], s46 offen sc1
buffer_load_dwordx4 v[152:155], v17, s[20:23], s46 offen offset:16 sc1
s_add_u32 s46, s46, 5120
buffer_load_dwordx4 v[156:159], v17, s[20:23], s46 offen sc1
buffer_load_dwordx4 v[160:163], v17, s[20:23], s46 offen offset:16 sc1
s_add_u32 s46, s46, 5120
buffer_load_dwordx4 v[164:167], v17, s[20:23], s46 offen sc1
buffer_load_dwordx4 v[168:171], v17, s[20:23], s46 offen offset:16 sc1
s_add_u32 s46, s46, 5120
buffer_load_dwordx4 v[20:23], v17, s[20:23], s46 offen sc1
buffer_load_dwordx4 v[24:27], v17, s[20:23], s46 offen offset:16 sc1
s_add_u32 s46, s46, 5120
buffer_load_dwordx4 v[28:31], v17, s[20:23], s46 offen sc1
buffer_load_dwordx4 v[32:35], v17, s[20:23], s46 offen offset:16 sc1
s_add_u32 s46, s46, 5120
buffer_load_dwordx4 v[36:39], v17, s[20:23], s46 offen sc1
buffer_load_dwordx4 v[40:43], v17, s[20:23], s46 offen offset:16 sc1
s_add_u32 s46, s46, 5120
buffer_load_dwordx4 v[44:47], v17, s[20:23], s46 offen sc1
buffer_load_dwordx4 v[48:51], v17, s[20:23], s46 offen offset:16 sc1
s_add_u32 s46, s46, 5120
buffer_load_dwordx4 v[52:55], v17, s[20:23], s46 offen sc1
buffer_load_dwordx4 v[56:59], v17, s[20:23], s46 offen offset:16 sc1
s_add_u32 s46, s46, 5120
s_waitcnt vmcnt(0)
v_pk_add_f32 v[84:85], v[84:85], v[92:93]
v_pk_add_f32 v[86:87], v[86:87], v[94:95]
v_pk_add_f32 v[88:89], v[88:89], v[96:97]
v_pk_add_f32 v[90:91], v[90:91], v[98:99]
v_pk_add_f32 v[84:85], v[84:85], v[100:101]
v_pk_add_f32 v[86:87], v[86:87], v[102:103]
v_pk_add_f32 v[88:89], v[88:89], v[104:105]
v_pk_add_f32 v[90:91], v[90:91], v[106:107]
v_pk_add_f32 v[84:85], v[84:85], v[108:109]
v_pk_add_f32 v[86:87], v[86:87], v[110:111]
v_pk_add_f32 v[88:89], v[88:89], v[112:113]
v_pk_add_f32 v[90:91], v[90:91], v[114:115]
v_pk_add_f32 v[84:85], v[84:85], v[116:117]
v_pk_add_f32 v[86:87], v[86:87], v[118:119]
v_pk_add_f32 v[88:89], v[88:89], v[120:121]
v_pk_add_f32 v[90:91], v[90:91], v[122:123]
v_pk_add_f32 v[84:85], v[84:85], v[124:125]
v_pk_add_f32 v[86:87], v[86:87], v[126:127]
v_pk_add_f32 v[88:89], v[88:89], v[128:129]
v_pk_add_f32 v[90:91], v[90:91], v[130:131]
v_pk_add_f32 v[84:85], v[84:85], v[132:133]
v_pk_add_f32 v[86:87], v[86:87], v[134:135]
v_pk_add_f32 v[88:89], v[88:89], v[136:137]
v_pk_add_f32 v[90:91], v[90:91], v[138:139]
v_pk_add_f32 v[84:85], v[84:85], v[140:141]
v_pk_add_f32 v[86:87], v[86:87], v[142:143]
v_pk_add_f32 v[88:89], v[88:89], v[144:145]
v_pk_add_f32 v[90:91], v[90:91], v[146:147]
v_pk_add_f32 v[84:85], v[84:85], v[148:149]
v_pk_add_f32 v[86:87], v[86:87], v[150:151]
v_pk_add_f32 v[88:89], v[88:89], v[152:153]
v_pk_add_f32 v[90:91], v[90:91], v[154:155]
v_pk_add_f32 v[84:85], v[84:85], v[156:157]
v_pk_add_f32 v[86:87], v[86:87], v[158:159]
v_pk_add_f32 v[88:89], v[88:89], v[160:161]
v_pk_add_f32 v[90:91], v[90:91], v[162:163]
v_pk_add_f32 v[84:85], v[84:85], v[164:165]
v_pk_add_f32 v[86:87], v[86:87], v[166:167]
v_pk_add_f32 v[88:89], v[88:89], v[168:169]
v_pk_add_f32 v[90:91], v[90:91], v[170:171]
v_pk_add_f32 v[84:85], v[84:85], v[20:21]
v_pk_add_f32 v[86:87], v[86:87], v[22:23]
v_pk_add_f32 v[88:89], v[88:89], v[24:25]
v_pk_add_f32 v[90:91], v[90:91], v[26:27]
v_pk_add_f32 v[84:85], v[84:85], v[28:29]
v_pk_add_f32 v[86:87], v[86:87], v[30:31]
v_pk_add_f32 v[88:89], v[88:89], v[32:33]
v_pk_add_f32 v[90:91], v[90:91], v[34:35]
v_pk_add_f32 v[84:85], v[84:85], v[36:37]
v_pk_add_f32 v[86:87], v[86:87], v[38:39]
v_pk_add_f32 v[88:89], v[88:89], v[40:41]
v_pk_add_f32 v[90:91], v[90:91], v[42:43]
v_pk_add_f32 v[84:85], v[84:85], v[44:45]
v_pk_add_f32 v[86:87], v[86:87], v[46:47]
v_pk_add_f32 v[88:89], v[88:89], v[48:49]
v_pk_add_f32 v[90:91], v[90:91], v[50:51]
v_pk_add_f32 v[84:85], v[84:85], v[52:53]
v_pk_add_f32 v[86:87], v[86:87], v[54:55]
v_pk_add_f32 v[88:89], v[88:89], v[56:57]
v_pk_add_f32 v[90:91], v[90:91], v[58:59]
v_mov_b32 v62, s55
v_cvt_pk_bf16_f32 v84, v84, v85
v_and_b32 v85, 0xffff0000, v84
v_lshlrev_b32 v84, 16, v84
v_pk_mul_f32 v[84:85], v[84:85], v[62:63] op_sel_hi:[1,0]
v_cvt_pk_bf16_f32 v84, v84, v85
v_and_b32 v85, 0xffff0000, v84
v_lshlrev_b32 v84, 16, v84
v_pk_add_f32 v[216:217], v[216:217], v[84:85]
v_cvt_pk_bf16_f32 v216, v216, v217
v_and_b32 v217, 0xffff0000, v216
v_lshlrev_b32 v216, 16, v216
v_cvt_pk_bf16_f32 v86, v86, v87
v_and_b32 v87, 0xffff0000, v86
v_lshlrev_b32 v86, 16, v86
v_pk_mul_f32 v[86:87], v[86:87], v[62:63] op_sel_hi:[1,0]
v_cvt_pk_bf16_f32 v86, v86, v87
v_and_b32 v87, 0xffff0000, v86
v_lshlrev_b32 v86, 16, v86
v_pk_add_f32 v[218:219], v[218:219], v[86:87]
v_cvt_pk_bf16_f32 v218, v218, v219
v_and_b32 v219, 0xffff0000, v218
v_lshlrev_b32 v218, 16, v218
v_cvt_pk_bf16_f32 v88, v88, v89
v_and_b32 v89, 0xffff0000, v88
v_lshlrev_b32 v88, 16, v88
v_pk_mul_f32 v[88:89], v[88:89], v[62:63] op_sel_hi:[1,0]
v_cvt_pk_bf16_f32 v88, v88, v89
v_and_b32 v89, 0xffff0000, v88
v_lshlrev_b32 v88, 16, v88
v_pk_add_f32 v[220:221], v[220:221], v[88:89]
v_cvt_pk_bf16_f32 v220, v220, v221
v_and_b32 v221, 0xffff0000, v220
v_lshlrev_b32 v220, 16, v220
v_cvt_pk_bf16_f32 v90, v90, v91
v_and_b32 v91, 0xffff0000, v90
v_lshlrev_b32 v90, 16, v90
v_pk_mul_f32 v[90:91], v[90:91], v[62:63] op_sel_hi:[1,0]
v_cvt_pk_bf16_f32 v90, v90, v91
v_and_b32 v91, 0xffff0000, v90
v_lshlrev_b32 v90, 16, v90
v_pk_add_f32 v[222:223], v[222:223], v[90:91]
v_cvt_pk_bf16_f32 v222, v222, v223
v_and_b32 v223, 0xffff0000, v222
v_lshlrev_b32 v222, 16, v222
s_mov_b64 exec, s[44:45]
L_g2_mu22:
s_cmp_ge_u32 s30, 2
s_cbranch_scc1 L_g2_mu24
v_cmp_eq_u32 vcc, s52, v203
s_nop 4
s_cmp_eq_u64 vcc, 0
s_cbranch_scc1 L_g2_mu24
s_mov_b64 s[40:41], vcc
s_cmp_lg_u32 s43, 0
s_cbranch_scc1 L_g2_mp24
s_mov_b32 s43, 1
s_mov_b32 s27, 0x20000
s_mov_b32 s56, 0xffff
s_mov_b32 s57, 0
L_pf25:
buffer_load_dword v17, v16, s[20:23], s36 offen sc1
s_waitcnt vmcnt(0)
v_cmp_eq_u32 vcc, s26, v17
s_sub_u32 s27, s27, 1
s_nop 3
s_andn2_b64 s[58:59], s[56:57], vcc
s_cmp_eq_u64 s[58:59], 0
s_cbranch_scc1 L_pfd25
s_sleep 2
s_cmp_lg_u32 s27, 0
s_cbranch_scc1 L_pf25
L_pfd25:
L_g2_mp24:
s_mov_b64 s[44:45], exec
s_mov_b64 exec, s[40:41]
v_mul_u32_u24 v17, 1280, v203
v_sub_u32 v17, v201, v17
v_lshlrev_b32 v17, 1, v17
s_mov_b32 s46, 11665408

buffer_load_dwordx4 v[84:87], v17, s[20:23], s46 offen sc1
buffer_load_dwordx4 v[88:91], v17, s[20:23], s46 offen offset:16 sc1
s_add_u32 s46, s46, 5120
buffer_load_dwordx4 v[92:95], v17, s[20:23], s46 offen sc1
buffer_load_dwordx4 v[96:99], v17, s[20:23], s46 offen offset:16 sc1
s_add_u32 s46, s46, 5120
buffer_load_dwordx4 v[100:103], v17, s[20:23], s46 offen sc1
buffer_load_dwordx4 v[104:107], v17, s[20:23], s46 offen offset:16 sc1
s_add_u32 s46, s46, 5120
buffer_load_dwordx4 v[108:111], v17, s[20:23], s46 offen sc1
buffer_load_dwordx4 v[112:115], v17, s[20:23], s46 offen offset:16 sc1
s_add_u32 s46, s46, 5120
buffer_load_dwordx4 v[116:119], v17, s[20:23], s46 offen sc1
buffer_load_dwordx4 v[120:123], v17, s[20:23], s46 offen offset:16 sc1
s_add_u32 s46, s46, 5120
buffer_load_dwordx4 v[124:127], v17, s[20:23], s46 offen sc1
buffer_load_dwordx4 v[128:131], v17, s[20:23], s46 offen offset:16 sc1
s_add_u32 s46, s46, 5120
buffer_load_dwordx4 v[132:135], v17, s[20:23], s46 offen sc1
buffer_load_dwordx4 v[136:139], v17, s[20:23], s46 offen offset:16 sc1
s_add_u32 s46, s46, 5120
buffer_load_dwordx4 v[140:143], v17, s[20:23], s46 offen sc1
buffer_load_dwordx4 v[144:147], v17, s[20:23], s46 offen offset:16 sc1
s_add_u32 s46, s46, 5120
buffer_load_dwordx4 v[148:151], v17, s[20:23], s46 offen sc1
buffer_load_dwordx4 v[152:155], v17, s[20:23], s46 offen offset:16 sc1
s_add_u32 s46, s46, 5120
buffer_load_dwordx4 v[156:159], v17, s[20:23], s46 offen sc1
buffer_load_dwordx4 v[160:163], v17, s[20:23], s46 offen offset:16 sc1
s_add_u32 s46, s46, 5120
buffer_load_dwordx4 v[164:167], v17, s[20:23], s46 offen sc1
buffer_load_dwordx4 v[168:171], v17, s[20:23], s46 offen offset:16 sc1
s_add_u32 s46, s46, 5120
buffer_load_dwordx4 v[20:23], v17, s[20:23], s46 offen sc1
buffer_load_dwordx4 v[24:27], v17, s[20:23], s46 offen offset:16 sc1
s_add_u32 s46, s46, 5120
buffer_load_dwordx4 v[28:31], v17, s[20:23], s46 offen sc1
buffer_load_dwordx4 v[32:35], v17, s[20:23], s46 offen offset:16 sc1
s_add_u32 s46, s46, 5120
buffer_load_dwordx4 v[36:39], v17, s[20:23], s46 offen sc1
buffer_load_dwordx4 v[40:43], v17, s[20:23], s46 offen offset:16 sc1
s_add_u32 s46, s46, 5120
buffer_load_dwordx4 v[44:47], v17, s[20:23], s46 offen sc1
buffer_load_dwordx4 v[48:51], v17, s[20:23], s46 offen offset:16 sc1
s_add_u32 s46, s46, 5120
buffer_load_dwordx4 v[52:55], v17, s[20:23], s46 offen sc1
buffer_load_dwordx4 v[56:59], v17, s[20:23], s46 offen offset:16 sc1
s_add_u32 s46, s46, 5120
s_waitcnt vmcnt(0)
v_pk_add_f32 v[84:85], v[84:85], v[92:93]
v_pk_add_f32 v[86:87], v[86:87], v[94:95]
v_pk_add_f32 v[88:89], v[88:89], v[96:97]
v_pk_add_f32 v[90:91], v[90:91], v[98:99]
v_pk_add_f32 v[84:85], v[84:85], v[100:101]
v_pk_add_f32 v[86:87], v[86:87], v[102:103]
v_pk_add_f32 v[88:89], v[88:89], v[104:105]
v_pk_add_f32 v[90:91], v[90:91], v[106:107]
v_pk_add_f32 v[84:85], v[84:85], v[108:109]
v_pk_add_f32 v[86:87], v[86:87], v[110:111]
v_pk_add_f32 v[88:89], v[88:89], v[112:113]
v_pk_add_f32 v[90:91], v[90:91], v[114:115]
v_pk_add_f32 v[84:85], v[84:85], v[116:117]
v_pk_add_f32 v[86:87], v[86:87], v[118:119]
v_pk_add_f32 v[88:89], v[88:89], v[120:121]
v_pk_add_f32 v[90:91], v[90:91], v[122:123]
v_pk_add_f32 v[84:85], v[84:85], v[124:125]
v_pk_add_f32 v[86:87], v[86:87], v[126:127]
v_pk_add_f32 v[88:89], v[88:89], v[128:129]
v_pk_add_f32 v[90:91], v[90:91], v[130:131]
v_pk_add_f32 v[84:85], v[84:85], v[132:133]
v_pk_add_f32 v[86:87], v[86:87], v[134:135]
v_pk_add_f32 v[88:89], v[88:89], v[136:137]
v_pk_add_f32 v[90:91], v[90:91], v[138:139]
v_pk_add_f32 v[84:85], v[84:85], v[140:141]
v_pk_add_f32 v[86:87], v[86:87], v[142:143]
v_pk_add_f32 v[88:89], v[88:89], v[144:145]
v_pk_add_f32 v[90:91], v[90:91], v[146:147]
v_pk_add_f32 v[84:85], v[84:85], v[148:149]
v_pk_add_f32 v[86:87], v[86:87], v[150:151]
v_pk_add_f32 v[88:89], v[88:89], v[152:153]
v_pk_add_f32 v[90:91], v[90:91], v[154:155]
v_pk_add_f32 v[84:85], v[84:85], v[156:157]
v_pk_add_f32 v[86:87], v[86:87], v[158:159]
v_pk_add_f32 v[88:89], v[88:89], v[160:161]
v_pk_add_f32 v[90:91], v[90:91], v[162:163]
v_pk_add_f32 v[84:85], v[84:85], v[164:165]
v_pk_add_f32 v[86:87], v[86:87], v[166:167]
v_pk_add_f32 v[88:89], v[88:89], v[168:169]
v_pk_add_f32 v[90:91], v[90:91], v[170:171]
v_pk_add_f32 v[84:85], v[84:85], v[20:21]
v_pk_add_f32 v[86:87], v[86:87], v[22:23]
v_pk_add_f32 v[88:89], v[88:89], v[24:25]
v_pk_add_f32 v[90:91], v[90:91], v[26:27]
v_pk_add_f32 v[84:85], v[84:85], v[28:29]
v_pk_add_f32 v[86:87], v[86:87], v[30:31]
v_pk_add_f32 v[88:89], v[88:89], v[32:33]
v_pk_add_f32 v[90:91], v[90:91], v[34:35]
v_pk_add_f32 v[84:85], v[84:85], v[36:37]
v_pk_add_f32 v[86:87], v[86:87], v[38:39]
v_pk_add_f32 v[88:89], v[88:89], v[40:41]
v_pk_add_f32 v[90:91], v[90:91], v[42:43]
v_pk_add_f32 v[84:85], v[84:85], v[44:45]
v_pk_add_f32 v[86:87], v[86:87], v[46:47]
v_pk_add_f32 v[88:89], v[88:89], v[48:49]
v_pk_add_f32 v[90:91], v[90:91], v[50:51]
v_pk_add_f32 v[84:85], v[84:85], v[52:53]
v_pk_add_f32 v[86:87], v[86:87], v[54:55]
v_pk_add_f32 v[88:89], v[88:89], v[56:57]
v_pk_add_f32 v[90:91], v[90:91], v[58:59]
v_mov_b32 v62, s54
v_cvt_pk_bf16_f32 v84, v84, v85
v_and_b32 v85, 0xffff0000, v84
v_lshlrev_b32 v84, 16, v84
v_pk_mul_f32 v[84:85], v[84:85], v[62:63] op_sel_hi:[1,0]
v_cvt_pk_bf16_f32 v84, v84, v85
v_and_b32 v85, 0xffff0000, v84
v_lshlrev_b32 v84, 16, v84
v_pk_add_f32 v[224:225], v[224:225], v[84:85]
v_cvt_pk_bf16_f32 v224, v224, v225
v_and_b32 v225, 0xffff0000, v224
v_lshlrev_b32 v224, 16, v224
v_cvt_pk_bf16_f32 v86, v86, v87
v_and_b32 v87, 0xffff0000, v86
v_lshlrev_b32 v86, 16, v86
v_pk_mul_f32 v[86:87], v[86:87], v[62:63] op_sel_hi:[1,0]
v_cvt_pk_bf16_f32 v86, v86, v87
v_and_b32 v87, 0xffff0000, v86
v_lshlrev_b32 v86, 16, v86
v_pk_add_f32 v[226:227], v[226:227], v[86:87]
v_cvt_pk_bf16_f32 v226, v226, v227
v_and_b32 v227, 0xffff0000, v226
v_lshlrev_b32 v226, 16, v226
v_cvt_pk_bf16_f32 v88, v88, v89
v_and_b32 v89, 0xffff0000, v88
v_lshlrev_b32 v88, 16, v88
v_pk_mul_f32 v[88:89], v[88:89], v[62:63] op_sel_hi:[1,0]
v_cvt_pk_bf16_f32 v88, v88, v89
v_and_b32 v89, 0xffff0000, v88
v_lshlrev_b32 v88, 16, v88
v_pk_add_f32 v[228:229], v[228:229], v[88:89]
v_cvt_pk_bf16_f32 v228, v228, v229
v_and_b32 v229, 0xffff0000, v228
v_lshlrev_b32 v228, 16, v228
v_cvt_pk_bf16_f32 v90, v90, v91
v_and_b32 v91, 0xffff0000, v90
v_lshlrev_b32 v90, 16, v90
v_pk_mul_f32 v[90:91], v[90:91], v[62:63] op_sel_hi:[1,0]
v_cvt_pk_bf16_f32 v90, v90, v91
v_and_b32 v91, 0xffff0000, v90
v_lshlrev_b32 v90, 16, v90
v_pk_add_f32 v[230:231], v[230:231], v[90:91]
v_cvt_pk_bf16_f32 v230, v230, v231
v_and_b32 v231, 0xffff0000, v230
v_lshlrev_b32 v230, 16, v230
s_mov_b64 exec, s[44:45]
L_g2_mu24:
s_cmp_ge_u32 s30, 2
s_cbranch_scc1 L_g2_mu26
v_cmp_eq_u32 vcc, s53, v203
s_nop 4
s_cmp_eq_u64 vcc, 0
s_cbranch_scc1 L_g2_mu26
s_mov_b64 s[40:41], vcc
s_cmp_lg_u32 s43, 0
s_cbranch_scc1 L_g2_mp26
s_mov_b32 s43, 1
s_mov_b32 s27, 0x20000
s_mov_b32 s56, 0xffff
s_mov_b32 s57, 0
L_pf27:
buffer_load_dword v17, v16, s[20:23], s36 offen sc1
s_waitcnt vmcnt(0)
v_cmp_eq_u32 vcc, s26, v17
s_sub_u32 s27, s27, 1
s_nop 3
s_andn2_b64 s[58:59], s[56:57], vcc
s_cmp_eq_u64 s[58:59], 0
s_cbranch_scc1 L_pfd27
s_sleep 2
s_cmp_lg_u32 s27, 0
s_cbranch_scc1 L_pf27
L_pfd27:
L_g2_mp26:
s_mov_b64 s[44:45], exec
s_mov_b64 exec, s[40:41]
v_mul_u32_u24 v17, 1280, v203
v_sub_u32 v17, v201, v17
v_lshlrev_b32 v17, 1, v17
s_mov_b32 s46, 11667968

buffer_load_dwordx4 v[84:87], v17, s[20:23], s46 offen sc1
buffer_load_dwordx4 v[88:91], v17, s[20:23], s46 offen offset:16 sc1
s_add_u32 s46, s46, 5120
buffer_load_dwordx4 v[92:95], v17, s[20:23], s46 offen sc1
buffer_load_dwordx4 v[96:99], v17, s[20:23], s46 offen offset:16 sc1
s_add_u32 s46, s46, 5120
buffer_load_dwordx4 v[100:103], v17, s[20:23], s46 offen sc1
buffer_load_dwordx4 v[104:107], v17, s[20:23], s46 offen offset:16 sc1
s_add_u32 s46, s46, 5120
buffer_load_dwordx4 v[108:111], v17, s[20:23], s46 offen sc1
buffer_load_dwordx4 v[112:115], v17, s[20:23], s46 offen offset:16 sc1
s_add_u32 s46, s46, 5120
buffer_load_dwordx4 v[116:119], v17, s[20:23], s46 offen sc1
buffer_load_dwordx4 v[120:123], v17, s[20:23], s46 offen offset:16 sc1
s_add_u32 s46, s46, 5120
buffer_load_dwordx4 v[124:127], v17, s[20:23], s46 offen sc1
buffer_load_dwordx4 v[128:131], v17, s[20:23], s46 offen offset:16 sc1
s_add_u32 s46, s46, 5120
buffer_load_dwordx4 v[132:135], v17, s[20:23], s46 offen sc1
buffer_load_dwordx4 v[136:139], v17, s[20:23], s46 offen offset:16 sc1
s_add_u32 s46, s46, 5120
buffer_load_dwordx4 v[140:143], v17, s[20:23], s46 offen sc1
buffer_load_dwordx4 v[144:147], v17, s[20:23], s46 offen offset:16 sc1
s_add_u32 s46, s46, 5120
buffer_load_dwordx4 v[148:151], v17, s[20:23], s46 offen sc1
buffer_load_dwordx4 v[152:155], v17, s[20:23], s46 offen offset:16 sc1
s_add_u32 s46, s46, 5120
buffer_load_dwordx4 v[156:159], v17, s[20:23], s46 offen sc1
buffer_load_dwordx4 v[160:163], v17, s[20:23], s46 offen offset:16 sc1
s_add_u32 s46, s46, 5120
buffer_load_dwordx4 v[164:167], v17, s[20:23], s46 offen sc1
buffer_load_dwordx4 v[168:171], v17, s[20:23], s46 offen offset:16 sc1
s_add_u32 s46, s46, 5120
buffer_load_dwordx4 v[20:23], v17, s[20:23], s46 offen sc1
buffer_load_dwordx4 v[24:27], v17, s[20:23], s46 offen offset:16 sc1
s_add_u32 s46, s46, 5120
buffer_load_dwordx4 v[28:31], v17, s[20:23], s46 offen sc1
buffer_load_dwordx4 v[32:35], v17, s[20:23], s46 offen offset:16 sc1
s_add_u32 s46, s46, 5120
buffer_load_dwordx4 v[36:39], v17, s[20:23], s46 offen sc1
buffer_load_dwordx4 v[40:43], v17, s[20:23], s46 offen offset:16 sc1
s_add_u32 s46, s46, 5120
buffer_load_dwordx4 v[44:47], v17, s[20:23], s46 offen sc1
buffer_load_dwordx4 v[48:51], v17, s[20:23], s46 offen offset:16 sc1
s_add_u32 s46, s46, 5120
buffer_load_dwordx4 v[52:55], v17, s[20:23], s46 offen sc1
buffer_load_dwordx4 v[56:59], v17, s[20:23], s46 offen offset:16 sc1
s_add_u32 s46, s46, 5120
s_waitcnt vmcnt(0)
v_pk_add_f32 v[84:85], v[84:85], v[92:93]
v_pk_add_f32 v[86:87], v[86:87], v[94:95]
v_pk_add_f32 v[88:89], v[88:89], v[96:97]
v_pk_add_f32 v[90:91], v[90:91], v[98:99]
v_pk_add_f32 v[84:85], v[84:85], v[100:101]
v_pk_add_f32 v[86:87], v[86:87], v[102:103]
v_pk_add_f32 v[88:89], v[88:89], v[104:105]
v_pk_add_f32 v[90:91], v[90:91], v[106:107]
v_pk_add_f32 v[84:85], v[84:85], v[108:109]
v_pk_add_f32 v[86:87], v[86:87], v[110:111]
v_pk_add_f32 v[88:89], v[88:89], v[112:113]
v_pk_add_f32 v[90:91], v[90:91], v[114:115]
v_pk_add_f32 v[84:85], v[84:85], v[116:117]
v_pk_add_f32 v[86:87], v[86:87], v[118:119]
v_pk_add_f32 v[88:89], v[88:89], v[120:121]
v_pk_add_f32 v[90:91], v[90:91], v[122:123]
v_pk_add_f32 v[84:85], v[84:85], v[124:125]
v_pk_add_f32 v[86:87], v[86:87], v[126:127]
v_pk_add_f32 v[88:89], v[88:89], v[128:129]
v_pk_add_f32 v[90:91], v[90:91], v[130:131]
v_pk_add_f32 v[84:85], v[84:85], v[132:133]
v_pk_add_f32 v[86:87], v[86:87], v[134:135]
v_pk_add_f32 v[88:89], v[88:89], v[136:137]
v_pk_add_f32 v[90:91], v[90:91], v[138:139]
v_pk_add_f32 v[84:85], v[84:85], v[140:141]
v_pk_add_f32 v[86:87], v[86:87], v[142:143]
v_pk_add_f32 v[88:89], v[88:89], v[144:145]
v_pk_add_f32 v[90:91], v[90:91], v[146:147]
v_pk_add_f32 v[84:85], v[84:85], v[148:149]
v_pk_add_f32 v[86:87], v[86:87], v[150:151]
v_pk_add_f32 v[88:89], v[88:89], v[152:153]
v_pk_add_f32 v[90:91], v[90:91], v[154:155]
v_pk_add_f32 v[84:85], v[84:85], v[156:157]
v_pk_add_f32 v[86:87], v[86:87], v[158:159]
v_pk_add_f32 v[88:89], v[88:89], v[160:161]
v_pk_add_f32 v[90:91], v[90:91], v[162:163]
v_pk_add_f32 v[84:85], v[84:85], v[164:165]
v_pk_add_f32 v[86:87], v[86:87], v[166:167]
v_pk_add_f32 v[88:89], v[88:89], v[168:169]
v_pk_add_f32 v[90:91], v[90:91], v[170:171]
v_pk_add_f32 v[84:85], v[84:85], v[20:21]
v_pk_add_f32 v[86:87], v[86:87], v[22:23]
v_pk_add_f32 v[88:89], v[88:89], v[24:25]
v_pk_add_f32 v[90:91], v[90:91], v[26:27]
v_pk_add_f32 v[84:85], v[84:85], v[28:29]
v_pk_add_f32 v[86:87], v[86:87], v[30:31]
v_pk_add_f32 v[88:89], v[88:89], v[32:33]
v_pk_add_f32 v[90:91], v[90:91], v[34:35]
v_pk_add_f32 v[84:85], v[84:85], v[36:37]
v_pk_add_f32 v[86:87], v[86:87], v[38:39]
v_pk_add_f32 v[88:89], v[88:89], v[40:41]
v_pk_add_f32 v[90:91], v[90:91], v[42:43]
v_pk_add_f32 v[84:85], v[84:85], v[44:45]
v_pk_add_f32 v[86:87], v[86:87], v[46:47]
v_pk_add_f32 v[88:89], v[88:89], v[48:49]
v_pk_add_f32 v[90:91], v[90:91], v[50:51]
v_pk_add_f32 v[84:85], v[84:85], v[52:53]
v_pk_add_f32 v[86:87], v[86:87], v[54:55]
v_pk_add_f32 v[88:89], v[88:89], v[56:57]
v_pk_add_f32 v[90:91], v[90:91], v[58:59]
v_mov_b32 v62, s55
v_cvt_pk_bf16_f32 v84, v84, v85
v_and_b32 v85, 0xffff0000, v84
v_lshlrev_b32 v84, 16, v84
v_pk_mul_f32 v[84:85], v[84:85], v[62:63] op_sel_hi:[1,0]
v_cvt_pk_bf16_f32 v84, v84, v85
v_and_b32 v85, 0xffff0000, v84
v_lshlrev_b32 v84, 16, v84
v_pk_add_f32 v[224:225], v[224:225], v[84:85]
v_cvt_pk_bf16_f32 v224, v224, v225
v_and_b32 v225, 0xffff0000, v224
v_lshlrev_b32 v224, 16, v224
v_cvt_pk_bf16_f32 v86, v86, v87
v_and_b32 v87, 0xffff0000, v86
v_lshlrev_b32 v86, 16, v86
v_pk_mul_f32 v[86:87], v[86:87], v[62:63] op_sel_hi:[1,0]
v_cvt_pk_bf16_f32 v86, v86, v87
v_and_b32 v87, 0xffff0000, v86
v_lshlrev_b32 v86, 16, v86
v_pk_add_f32 v[226:227], v[226:227], v[86:87]
v_cvt_pk_bf16_f32 v226, v226, v227
v_and_b32 v227, 0xffff0000, v226
v_lshlrev_b32 v226, 16, v226
v_cvt_pk_bf16_f32 v88, v88, v89
v_and_b32 v89, 0xffff0000, v88
v_lshlrev_b32 v88, 16, v88
v_pk_mul_f32 v[88:89], v[88:89], v[62:63] op_sel_hi:[1,0]
v_cvt_pk_bf16_f32 v88, v88, v89
v_and_b32 v89, 0xffff0000, v88
v_lshlrev_b32 v88, 16, v88
v_pk_add_f32 v[228:229], v[228:229], v[88:89]
v_cvt_pk_bf16_f32 v228, v228, v229
v_and_b32 v229, 0xffff0000, v228
v_lshlrev_b32 v228, 16, v228
v_cvt_pk_bf16_f32 v90, v90, v91
v_and_b32 v91, 0xffff0000, v90
v_lshlrev_b32 v90, 16, v90
v_pk_mul_f32 v[90:91], v[90:91], v[62:63] op_sel_hi:[1,0]
v_cvt_pk_bf16_f32 v90, v90, v91
v_and_b32 v91, 0xffff0000, v90
v_lshlrev_b32 v90, 16, v90
v_pk_add_f32 v[230:231], v[230:231], v[90:91]
v_cvt_pk_bf16_f32 v230, v230, v231
v_and_b32 v231, 0xffff0000, v230
v_lshlrev_b32 v230, 16, v230
s_mov_b64 exec, s[44:45]
L_g2_mu26:
L_g2_nomoe:
s_cmp_eq_u32 s30, 4
s_cbranch_scc0 L_g2_nopoll
s_mov_b32 s27, 0x20000
s_mov_b32 s56, 0xffffffff
s_mov_b32 s57, 0xffffffff
buffer_load_dword v17, v16, s[20:23], s95 offen sc1
s_sleep 6
L_pf28:
buffer_load_dword v18, v16, s[20:23], s95 offen sc1
s_waitcnt vmcnt(1)
v_cmp_eq_u32 vcc, s26, v17
s_sub_u32 s27, s27, 1
s_nop 3
s_andn2_b64 s[58:59], s[56:57], vcc
s_cmp_eq_u64 s[58:59], 0
s_cbranch_scc1 L_pfd28
buffer_load_dword v17, v16, s[20:23], s95 offen sc1
s_waitcnt vmcnt(1)
v_cmp_eq_u32 vcc, s26, v18
s_nop 4
s_andn2_b64 s[58:59], s[56:57], vcc
s_cmp_eq_u64 s[58:59], 0
s_cbranch_scc1 L_pfd28
s_cmp_lg_u32 s27, 0
s_cbranch_scc1 L_pf28
L_pfd28:
s_waitcnt vmcnt(1)
s_branch L_g2_pb
L_g2_nopoll:
s_waitcnt vmcnt(0)
L_g2_pb:
s_barrier
ds_read_b64_tr_b16 v[124:125], v83 offset:0
ds_read_b64_tr_b16 v[126:127], v83 offset:640
ds_read_b64_tr_b16 v[128:129], v83 offset:32
ds_read_b64_tr_b16 v[130:131], v83 offset:672
ds_read_b64_tr_b16 v[132:133], v83 offset:64
ds_read_b64_tr_b16 v[134:135], v83 offset:704
ds_read_b64_tr_b16 v[136:137], v83 offset:96
ds_read_b64_tr_b16 v[138:139], v83 offset:736
ds_read_b64_tr_b16 v[140:141], v83 offset:128
ds_read_b64_tr_b16 v[142:143], v83 offset:768
s_lshr_b32 s37, s30, 2
s_lshl_b32 s38, s37, 18
s_add_u32 s38, s38, 8388608
s_lshl_b32 s39, s37, 16
s_add_u32 s39, s39, 10485760
s_add_u32 s40, s38, 0
buffer_load_dwordx4 v[84:87], v82, s[20:23], s40 offen sc1
s_add_u32 s40, s38, 32768
buffer_load_dwordx4 v[88:91], v82, s[20:23], s40 offen sc1
s_add_u32 s40, s38, 65536
buffer_load_dwordx4 v[92:95], v82, s[20:23], s40 offen sc1
s_add_u32 s40, s38, 98304
buffer_load_dwordx4 v[96:99], v82, s[20:23], s40 offen sc1
s_add_u32 s40, s38, 131072
buffer_load_dwordx4 v[100:103], v82, s[20:23], s40 offen sc1
s_add_u32 s40, s38, 163840
buffer_load_dwordx4 v[104:107], v82, s[20:23], s40 offen sc1
s_add_u32 s40, s38, 196608
buffer_load_dwordx4 v[108:111], v82, s[20:23], s40 offen sc1
s_add_u32 s40, s38, 229376
buffer_load_dwordx4 v[112:115], v82, s[20:23], s40 offen sc1
s_add_u32 s40, s39, 0
buffer_load_dwordx4 v[116:119], v81, s[20:23], s40 offen sc1
s_add_u32 s40, s39, 32768
buffer_load_dwordx4 v[120:123], v81, s[20:23], s40 offen sc1
v_and_b32 v3, 15, v2
s_and_b32 s36, s30, 3
s_lshl_b32 s36, s36, 4
v_add_u32 v3, s36, v3
v_mul_u32_u24 v3, 336, v3
v_lshlrev_b32 v4, 4, v4
v_add_u32 v3, v3, v4
s_mul_i32 s37, s37, 21504
v_add_u32 v3, s37, v3
ds_read_b64_tr_b16 v[144:145], v83 offset:1280
ds_read_b64_tr_b16 v[146:147], v83 offset:1920
ds_read_b64_tr_b16 v[148:149], v83 offset:1312
ds_read_b64_tr_b16 v[150:151], v83 offset:1952
ds_read_b64_tr_b16 v[152:153], v83 offset:1344
ds_read_b64_tr_b16 v[154:155], v83 offset:1984
ds_read_b64_tr_b16 v[156:157], v83 offset:1376
ds_read_b64_tr_b16 v[158:159], v83 offset:2016
ds_read_b64_tr_b16 v[160:161], v83 offset:1408
ds_read_b64_tr_b16 v[162:163], v83 offset:2048
s_waitcnt lgkmcnt(10) vmcnt(9)
v_mfma_f32_16x16x32_bf16 v[44:47], v[124:127], v[84:87], 0
v_mfma_f32_16x16x32_bf16 v[48:51], v[128:131], v[84:87], 0
v_mfma_f32_16x16x32_bf16 v[52:55], v[132:135], v[84:87], 0
v_mfma_f32_16x16x32_bf16 v[56:59], v[136:139], v[84:87], 0
v_mfma_f32_16x16x32_bf16 v[60:63], v[140:143], v[84:87], 0
ds_read_b64_tr_b16 v[124:125], v83 offset:3200
ds_read_b64_tr_b16 v[126:127], v83 offset:3840
ds_read_b64_tr_b16 v[128:129], v83 offset:3232
ds_read_b64_tr_b16 v[130:131], v83 offset:3872
ds_read_b64_tr_b16 v[132:133], v83 offset:3264
ds_read_b64_tr_b16 v[134:135], v83 offset:3904
ds_read_b64_tr_b16 v[136:137], v83 offset:3296
ds_read_b64_tr_b16 v[138:139], v83 offset:3936
ds_read_b64_tr_b16 v[140:141], v83 offset:3328
ds_read_b64_tr_b16 v[142:143], v83 offset:3968
s_waitcnt lgkmcnt(10) vmcnt(8)
v_mfma_f32_16x16x32_bf16 v[44:47], v[144:147], v[88:91], v[44:47]
v_mfma_f32_16x16x32_bf16 v[48:51], v[148:151], v[88:91], v[48:51]
v_mfma_f32_16x16x32_bf16 v[52:55], v[152:155], v[88:91], v[52:55]
v_mfma_f32_16x16x32_bf16 v[56:59], v[156:159], v[88:91], v[56:59]
v_mfma_f32_16x16x32_bf16 v[60:63], v[160:163], v[88:91], v[60:63]
ds_read_b64_tr_b16 v[144:145], v83 offset:4480
ds_read_b64_tr_b16 v[146:147], v83 offset:5120
ds_read_b64_tr_b16 v[148:149], v83 offset:4512
ds_read_b64_tr_b16 v[150:151], v83 offset:5152
ds_read_b64_tr_b16 v[152:153], v83 offset:4544
ds_read_b64_tr_b16 v[154:155], v83 offset:5184
ds_read_b64_tr_b16 v[156:157], v83 offset:4576
ds_read_b64_tr_b16 v[158:159], v83 offset:5216
ds_read_b64_tr_b16 v[160:161], v83 offset:4608
ds_read_b64_tr_b16 v[162:163], v83 offset:5248
s_waitcnt lgkmcnt(10) vmcnt(7)
v_mfma_f32_16x16x32_bf16 v[44:47], v[124:127], v[92:95], v[44:47]
v_mfma_f32_16x16x32_bf16 v[48:51], v[128:131], v[92:95], v[48:51]
v_mfma_f32_16x16x32_bf16 v[52:55], v[132:135], v[92:95], v[52:55]
v_mfma_f32_16x16x32_bf16 v[56:59], v[136:139], v[92:95], v[56:59]
v_mfma_f32_16x16x32_bf16 v[60:63], v[140:143], v[92:95], v[60:63]
ds_read_b64_tr_b16 v[124:125], v83 offset:6400
ds_read_b64_tr_b16 v[126:127], v83 offset:7040
ds_read_b64_tr_b16 v[128:129], v83 offset:6432
ds_read_b64_tr_b16 v[130:131], v83 offset:7072
ds_read_b64_tr_b16 v[132:133], v83 offset:6464
ds_read_b64_tr_b16 v[134:135], v83 offset:7104
ds_read_b64_tr_b16 v[136:137], v83 offset:6496
ds_read_b64_tr_b16 v[138:139], v83 offset:7136
ds_read_b64_tr_b16 v[140:141], v83 offset:6528
ds_read_b64_tr_b16 v[142:143], v83 offset:7168
s_waitcnt lgkmcnt(10) vmcnt(6)
v_mfma_f32_16x16x32_bf16 v[44:47], v[144:147], v[96:99], v[44:47]
v_mfma_f32_16x16x32_bf16 v[48:51], v[148:151], v[96:99], v[48:51]
v_mfma_f32_16x16x32_bf16 v[52:55], v[152:155], v[96:99], v[52:55]
v_mfma_f32_16x16x32_bf16 v[56:59], v[156:159], v[96:99], v[56:59]
v_mfma_f32_16x16x32_bf16 v[60:63], v[160:163], v[96:99], v[60:63]
ds_read_b64_tr_b16 v[144:145], v83 offset:7680
ds_read_b64_tr_b16 v[146:147], v83 offset:8320
ds_read_b64_tr_b16 v[148:149], v83 offset:7712
ds_read_b64_tr_b16 v[150:151], v83 offset:8352
ds_read_b64_tr_b16 v[152:153], v83 offset:7744
ds_read_b64_tr_b16 v[154:155], v83 offset:8384
ds_read_b64_tr_b16 v[156:157], v83 offset:7776
ds_read_b64_tr_b16 v[158:159], v83 offset:8416
ds_read_b64_tr_b16 v[160:161], v83 offset:7808
ds_read_b64_tr_b16 v[162:163], v83 offset:8448
s_waitcnt lgkmcnt(10) vmcnt(5)
v_mfma_f32_16x16x32_bf16 v[44:47], v[124:127], v[100:103], v[44:47]
v_mfma_f32_16x16x32_bf16 v[48:51], v[128:131], v[100:103], v[48:51]
v_mfma_f32_16x16x32_bf16 v[52:55], v[132:135], v[100:103], v[52:55]
v_mfma_f32_16x16x32_bf16 v[56:59], v[136:139], v[100:103], v[56:59]
v_mfma_f32_16x16x32_bf16 v[60:63], v[140:143], v[100:103], v[60:63]
ds_read_b64_tr_b16 v[124:125], v83 offset:9600
ds_read_b64_tr_b16 v[126:127], v83 offset:10240
ds_read_b64_tr_b16 v[128:129], v83 offset:9632
ds_read_b64_tr_b16 v[130:131], v83 offset:10272
ds_read_b64_tr_b16 v[132:133], v83 offset:9664
ds_read_b64_tr_b16 v[134:135], v83 offset:10304
ds_read_b64_tr_b16 v[136:137], v83 offset:9696
ds_read_b64_tr_b16 v[138:139], v83 offset:10336
ds_read_b64_tr_b16 v[140:141], v83 offset:9728
ds_read_b64_tr_b16 v[142:143], v83 offset:10368
s_waitcnt lgkmcnt(10) vmcnt(4)
v_mfma_f32_16x16x32_bf16 v[44:47], v[144:147], v[104:107], v[44:47]
v_mfma_f32_16x16x32_bf16 v[48:51], v[148:151], v[104:107], v[48:51]
v_mfma_f32_16x16x32_bf16 v[52:55], v[152:155], v[104:107], v[52:55]
v_mfma_f32_16x16x32_bf16 v[56:59], v[156:159], v[104:107], v[56:59]
v_mfma_f32_16x16x32_bf16 v[60:63], v[160:163], v[104:107], v[60:63]
ds_read_b64_tr_b16 v[144:145], v83 offset:10880
ds_read_b64_tr_b16 v[146:147], v83 offset:11520
ds_read_b64_tr_b16 v[148:149], v83 offset:10912
ds_read_b64_tr_b16 v[150:151], v83 offset:11552
ds_read_b64_tr_b16 v[152:153], v83 offset:10944
ds_read_b64_tr_b16 v[154:155], v83 offset:11584
ds_read_b64_tr_b16 v[156:157], v83 offset:10976
ds_read_b64_tr_b16 v[158:159], v83 offset:11616
ds_read_b64_tr_b16 v[160:161], v83 offset:11008
ds_read_b64_tr_b16 v[162:163], v83 offset:11648
s_waitcnt lgkmcnt(10) vmcnt(3)
v_mfma_f32_16x16x32_bf16 v[44:47], v[124:127], v[108:111], v[44:47]
v_mfma_f32_16x16x32_bf16 v[48:51], v[128:131], v[108:111], v[48:51]
v_mfma_f32_16x16x32_bf16 v[52:55], v[132:135], v[108:111], v[52:55]
v_mfma_f32_16x16x32_bf16 v[56:59], v[136:139], v[108:111], v[56:59]
v_mfma_f32_16x16x32_bf16 v[60:63], v[140:143], v[108:111], v[60:63]
ds_read_b64_tr_b16 v[124:125], v83 offset:2560
ds_read_b64_tr_b16 v[126:127], v83 offset:5760
ds_read_b64_tr_b16 v[128:129], v83 offset:2592
ds_read_b64_tr_b16 v[130:131], v83 offset:5792
ds_read_b64_tr_b16 v[132:133], v83 offset:2624
ds_read_b64_tr_b16 v[134:135], v83 offset:5824
ds_read_b64_tr_b16 v[136:137], v83 offset:2656
ds_read_b64_tr_b16 v[138:139], v83 offset:5856
ds_read_b64_tr_b16 v[140:141], v83 offset:2688
ds_read_b64_tr_b16 v[142:143], v83 offset:5888
s_waitcnt lgkmcnt(10) vmcnt(2)
v_mfma_f32_16x16x32_bf16 v[44:47], v[144:147], v[112:115], v[44:47]
v_mfma_f32_16x16x32_bf16 v[48:51], v[148:151], v[112:115], v[48:51]
v_mfma_f32_16x16x32_bf16 v[52:55], v[152:155], v[112:115], v[52:55]
v_mfma_f32_16x16x32_bf16 v[56:59], v[156:159], v[112:115], v[56:59]
v_mfma_f32_16x16x32_bf16 v[60:63], v[160:163], v[112:115], v[60:63]
ds_read_b64_tr_b16 v[144:145], v83 offset:8960
ds_read_b64_tr_b16 v[146:147], v83 offset:12160
ds_read_b64_tr_b16 v[148:149], v83 offset:8992
ds_read_b64_tr_b16 v[150:151], v83 offset:12192
ds_read_b64_tr_b16 v[152:153], v83 offset:9024
ds_read_b64_tr_b16 v[154:155], v83 offset:12224
ds_read_b64_tr_b16 v[156:157], v83 offset:9056
ds_read_b64_tr_b16 v[158:159], v83 offset:12256
ds_read_b64_tr_b16 v[160:161], v83 offset:9088
ds_read_b64_tr_b16 v[162:163], v83 offset:12288
s_waitcnt lgkmcnt(10) vmcnt(1)
v_mfma_f32_16x16x32_bf16 v[44:47], v[124:127], v[116:119], v[44:47]
v_mfma_f32_16x16x32_bf16 v[48:51], v[128:131], v[116:119], v[48:51]
v_mfma_f32_16x16x32_bf16 v[52:55], v[132:135], v[116:119], v[52:55]
v_mfma_f32_16x16x32_bf16 v[56:59], v[136:139], v[116:119], v[56:59]
v_mfma_f32_16x16x32_bf16 v[60:63], v[140:143], v[116:119], v[60:63]
s_waitcnt lgkmcnt(0) vmcnt(0)
v_mfma_f32_16x16x32_bf16 v[44:47], v[144:147], v[120:123], v[44:47]
v_mfma_f32_16x16x32_bf16 v[48:51], v[148:151], v[120:123], v[48:51]
v_mfma_f32_16x16x32_bf16 v[52:55], v[152:155], v[120:123], v[52:55]
v_mfma_f32_16x16x32_bf16 v[56:59], v[156:159], v[120:123], v[56:59]
v_mfma_f32_16x16x32_bf16 v[60:63], v[160:163], v[120:123], v[60:63]
s_nop 3
ds_write_b128 v3, v[44:47] offset:0
ds_write_b128 v3, v[48:51] offset:64
ds_write_b128 v3, v[52:55] offset:128
ds_write_b128 v3, v[56:59] offset:192
ds_write_b128 v3, v[60:63] offset:256
s_waitcnt lgkmcnt(0)
s_barrier
s_cmp_ge_u32 s30, 2
s_cbranch_scc1 L_ep_one
ds_read_b128 v[16:19], v204
ds_read_b128 v[20:23], v204 offset:16
ds_read_b128 v[24:27], v204 offset:21504
ds_read_b128 v[28:31], v204 offset:21520
ds_read_b128 v[48:51], v205
ds_read_b128 v[52:55], v205 offset:16
ds_read_b128 v[56:59], v205 offset:21504
ds_read_b128 v[60:63], v205 offset:21520
s_waitcnt lgkmcnt(4)
v_pk_add_f32 v[16:17], v[16:17], v[24:25]
v_pk_add_f32 v[18:19], v[18:19], v[26:27]
v_pk_add_f32 v[20:21], v[20:21], v[28:29]
v_pk_add_f32 v[22:23], v[22:23], v[30:31]
v_cvt_pk_bf16_f32 v16, v16, v17
v_and_b32 v17, 0xffff0000, v16
v_lshlrev_b32 v16, 16, v16
v_cvt_pk_bf16_f32 v18, v18, v19
v_and_b32 v19, 0xffff0000, v18
v_lshlrev_b32 v18, 16, v18
v_cvt_pk_bf16_f32 v20, v20, v21
v_and_b32 v21, 0xffff0000, v20
v_lshlrev_b32 v20, 16, v20
v_cvt_pk_bf16_f32 v22, v22, v23
v_and_b32 v23, 0xffff0000, v22
v_lshlrev_b32 v22, 16, v22
v_pk_add_f32 v[16:17], v[16:17], v[232:233]
v_pk_add_f32 v[18:19], v[18:19], v[234:235]
v_pk_add_f32 v[20:21], v[20:21], v[236:237]
v_pk_add_f32 v[22:23], v[22:23], v[238:239]
v_cvt_pk_bf16_f32 v16, v16, v17
v_and_b32 v17, 0xffff0000, v16
v_lshlrev_b32 v16, 16, v16
v_cvt_pk_bf16_f32 v18, v18, v19
v_and_b32 v19, 0xffff0000, v18
v_lshlrev_b32 v18, 16, v18
v_cvt_pk_bf16_f32 v20, v20, v21
v_and_b32 v21, 0xffff0000, v20
v_lshlrev_b32 v20, 16, v20
v_cvt_pk_bf16_f32 v22, v22, v23
v_and_b32 v23, 0xffff0000, v22
v_lshlrev_b32 v22, 16, v22
v_pk_add_f32 v[16:17], v[16:17], v[216:217]
v_pk_add_f32 v[18:19], v[18:19], v[218:219]
v_pk_add_f32 v[20:21], v[20:21], v[220:221]
v_pk_add_f32 v[22:23], v[22:23], v[222:223]
v_cvt_pk_bf16_f32 v24, v16, v17
v_cvt_pk_bf16_f32 v25, v18, v19
v_cvt_pk_bf16_f32 v26, v20, v21
v_cvt_pk_bf16_f32 v27, v22, v23
buffer_store_dwordx4 v[24:27], v200, s[12:15], 0 offen
s_waitcnt lgkmcnt(0)
v_pk_add_f32 v[48:49], v[48:49], v[56:57]
v_pk_add_f32 v[50:51], v[50:51], v[58:59]
v_pk_add_f32 v[52:53], v[52:53], v[60:61]
v_pk_add_f32 v[54:55], v[54:55], v[62:63]
v_cvt_pk_bf16_f32 v48, v48, v49
v_and_b32 v49, 0xffff0000, v48
v_lshlrev_b32 v48, 16, v48
v_cvt_pk_bf16_f32 v50, v50, v51
v_and_b32 v51, 0xffff0000, v50
v_lshlrev_b32 v50, 16, v50
v_cvt_pk_bf16_f32 v52, v52, v53
v_and_b32 v53, 0xffff0000, v52
v_lshlrev_b32 v52, 16, v52
v_cvt_pk_bf16_f32 v54, v54, v55
v_and_b32 v55, 0xffff0000, v54
v_lshlrev_b32 v54, 16, v54
v_pk_add_f32 v[48:49], v[48:49], v[240:241]
v_pk_add_f32 v[50:51], v[50:51], v[242:243]
v_pk_add_f32 v[52:53], v[52:53], v[244:245]
v_pk_add_f32 v[54:55], v[54:55], v[246:247]
v_cvt_pk_bf16_f32 v48, v48, v49
v_and_b32 v49, 0xffff0000, v48
v_lshlrev_b32 v48, 16, v48
v_cvt_pk_bf16_f32 v50, v50, v51
v_and_b32 v51, 0xffff0000, v50
v_lshlrev_b32 v50, 16, v50
v_cvt_pk_bf16_f32 v52, v52, v53
v_and_b32 v53, 0xffff0000, v52
v_lshlrev_b32 v52, 16, v52
v_cvt_pk_bf16_f32 v54, v54, v55
v_and_b32 v55, 0xffff0000, v54
v_lshlrev_b32 v54, 16, v54
v_pk_add_f32 v[48:49], v[48:49], v[224:225]
v_pk_add_f32 v[50:51], v[50:51], v[226:227]
v_pk_add_f32 v[52:53], v[52:53], v[228:229]
v_pk_add_f32 v[54:55], v[54:55], v[230:231]
v_cvt_pk_bf16_f32 v56, v48, v49
v_cvt_pk_bf16_f32 v57, v50, v51
v_cvt_pk_bf16_f32 v58, v52, v53
v_cvt_pk_bf16_f32 v59, v54, v55
buffer_store_dwordx4 v[56:59], v201, s[12:15], 0 offen
s_branch L_ep_done
L_ep_one:
ds_read_b128 v[16:19], v204
ds_read_b128 v[20:23], v204 offset:16
ds_read_b128 v[24:27], v204 offset:21504
ds_read_b128 v[28:31], v204 offset:21520
s_waitcnt lgkmcnt(0)
v_pk_add_f32 v[16:17], v[16:17], v[24:25]
v_pk_add_f32 v[18:19], v[18:19], v[26:27]
v_pk_add_f32 v[20:21], v[20:21], v[28:29]
v_pk_add_f32 v[22:23], v[22:23], v[30:31]
v_cvt_pk_bf16_f32 v16, v16, v17
v_and_b32 v17, 0xffff0000, v16
v_lshlrev_b32 v16, 16, v16
v_cvt_pk_bf16_f32 v18, v18, v19
v_and_b32 v19, 0xffff0000, v18
v_lshlrev_b32 v18, 16, v18
v_cvt_pk_bf16_f32 v20, v20, v21
v_and_b32 v21, 0xffff0000, v20
v_lshlrev_b32 v20, 16, v20
v_cvt_pk_bf16_f32 v22, v22, v23
v_and_b32 v23, 0xffff0000, v22
v_lshlrev_b32 v22, 16, v22
v_pk_add_f32 v[16:17], v[16:17], v[232:233]
v_pk_add_f32 v[18:19], v[18:19], v[234:235]
v_pk_add_f32 v[20:21], v[20:21], v[236:237]
v_pk_add_f32 v[22:23], v[22:23], v[238:239]
v_cvt_pk_bf16_f32 v16, v16, v17
v_and_b32 v17, 0xffff0000, v16
v_lshlrev_b32 v16, 16, v16
v_cvt_pk_bf16_f32 v18, v18, v19
v_and_b32 v19, 0xffff0000, v18
v_lshlrev_b32 v18, 16, v18
v_cvt_pk_bf16_f32 v20, v20, v21
v_and_b32 v21, 0xffff0000, v20
v_lshlrev_b32 v20, 16, v20
v_cvt_pk_bf16_f32 v22, v22, v23
v_and_b32 v23, 0xffff0000, v22
v_lshlrev_b32 v22, 16, v22
v_pk_add_f32 v[16:17], v[16:17], v[216:217]
v_pk_add_f32 v[18:19], v[18:19], v[218:219]
v_pk_add_f32 v[20:21], v[20:21], v[220:221]
v_pk_add_f32 v[22:23], v[22:23], v[222:223]
v_cvt_pk_bf16_f32 v24, v16, v17
v_cvt_pk_bf16_f32 v25, v18, v19
v_cvt_pk_bf16_f32 v26, v20, v21
v_cvt_pk_bf16_f32 v27, v22, v23
buffer_store_dwordx4 v[24:27], v200, s[12:15], 0 offen
L_ep_done:
L_end:
s_endpgm
L_codeend:
.section .rodata,"a"
.p2align 6
.amdhsa_kernel parallel_sum__sliding_block__moe_arch_mod__prompt_kernel
  .amdhsa_next_free_vgpr 256
  .amdhsa_next_free_sgpr 102
  .amdhsa_accum_offset 256
  .amdhsa_group_segment_fixed_size 0
  .amdhsa_kernarg_size 88
  .amdhsa_user_sgpr_count 2
  .amdhsa_user_sgpr_kernarg_segment_ptr 1
  .amdhsa_system_sgpr_workgroup_id_x 1
.end_amdhsa_kernel
```
